```python
import torch

def _softmax(x, axis=-1):
    return torch.softmax(x, dim=axis)

def _gelu(x):
    return torch.nn.functional.gelu(x, approximate='tanh')

def _silu(x):
    return torch.nn.functional.silu(x)

def _sigmoid(x):
    return torch.sigmoid(x)

def _layernorm(x, axis=-1, eps=1e-05):
    m = x.mean(dim=axis, keepdim=True)
    v = x.var(dim=axis, keepdim=True, unbiased=False)
    return (x - m) / torch.sqrt(v + eps)

def _scatter_add(tgt, idx, src, axis=0):
    return tgt.clone().index_add_(axis, idx, src)

def _segment_sum(src, seg, n):
    out = torch.zeros((n,) + src.shape[1:], dtype=src.dtype)
    return out.index_add_(0, seg, src)

def _pad(x, pw):
    flat = tuple((v for pair in reversed(pw) for v in pair))
    return torch.nn.functional.pad(x, flat)
kernel_name = 'standalone__window_attn_twins__vision'

def setup_inputs():

    _w = lambda a: (lambda t: t.to(torch.bfloat16) if t.is_floating_point() else t)(torch.as_tensor(a))
    H = W = 224 // 8 * 8
    C = 96
    return {'x': _w((lambda *s: torch.randn(*s, dtype=torch.bfloat16) * 0.8)(1, H, W, C)), 'wq': _w((lambda *s: torch.randn(*s, dtype=torch.bfloat16) * 0.8)(C, C)), 'wkv': _w((lambda *s: torch.randn(*s, dtype=torch.bfloat16) * 0.8)(C, 2 * C)), 'wo': _w((lambda *s: torch.randn(*s, dtype=torch.bfloat16) * 0.05)(C, C))}

def reference(x, wq, wkv, wo):
    B, H, W, C = x.shape
    win = 8
    nh, nw = (H // win, W // win)
    xs = x.reshape(B, nh, win, nw, win, C).mean(axis=(2, 4)).reshape(B, nh * nw, C)
    q = x.reshape(B, H * W, C) @ wq
    kv = xs @ wkv
    k, v = (kv[..., :C].clone(), kv[..., C:].clone())
    scale = C ** (-0.5)
    p = _softmax(torch.einsum('bqc,bkc->bqk', q, k) * scale, axis=-1)
    o = torch.einsum('bqk,bkc->bqc', p, v) @ wo
    return o.reshape(B, H, W, C)
```

```asm
; @launch grid=(252,1,1) block=(256,1,1) lds=146944
.amdgcn_target "amdgcn-amd-amdhsa--gfx950"
.text
.globl standalone__window_attn_twins__vision_kernel
.p2align 8
.type standalone__window_attn_twins__vision_kernel,@function
standalone__window_attn_twins__vision_kernel:
    s_cmp_ge_u32 s2, 252
    s_cbranch_scc1 L_end
    s_load_dwordx8 s[4:11], s[0:1], 0
    s_load_dwordx2 s[12:13], s[0:1], 32
    s_load_dwordx4 s[44:47], s[0:1], 40
    v_lshrrev_b32 v2, 6, v0
    v_and_b32 v1, 63, v0
    v_readfirstlane_b32 s14, v2
    s_mov_b32 s18, 9633792
    s_mov_b32 s19, 0x20000
    s_mov_b32 s26, 348672
    s_mov_b32 s27, 0x20000
    s_mov_b32 s50, 256
    s_mov_b32 s51, 0x20000
    s_waitcnt lgkmcnt(0)
    s_mov_b32 s16, s4
    s_mov_b32 s17, s5
    s_mov_b32 s24, s46
    s_mov_b32 s25, s47
    s_mov_b32 s48, s44
    s_mov_b32 s49, s45
    s_cmp_lt_u32 s2, 28
    s_cbranch_scc1 L_spare

    s_sub_u32 s3, s2, 28
    v_lshlrev_b32 v16, 4, v1
    s_lshr_b32 s55, s3, 3
    s_and_b32 s56, s3, 7
    s_mul_i32 s39, s55, 344064
    s_mul_i32 s57, s56, 6144
    s_mov_b32 s40, 43008
    s_cmp_eq_u32 s56, 7
    s_cselect_b32 s57, 301056, s57
    s_cselect_b32 s40, 6144, s40
    s_add_u32 s39, s39, s57
    s_cmp_eq_u32 s14, 3
    s_cbranch_scc1 L_x_w3
    s_cmp_ge_u32 s3, 120
    s_cbranch_scc1 L_cons2

    s_mul_i32 s6, s14, 3
    s_mul_i32 s7, s6, 6144
    s_mul_i32 s6, s6, s40
    s_add_u32 s6, s6, s39
    s_add_u32 s7, s7, 78336
    s_mov_b32 m0, s7
    s_add_u32 s8, s6, 4096

    buffer_load_dwordx4 v16, s[16:19], s6 offen offset:0 nt lds
    buffer_load_dwordx4 v16, s[16:19], s6 offen offset:1024 nt lds
    buffer_load_dwordx4 v16, s[16:19], s6 offen offset:2048 nt lds
    buffer_load_dwordx4 v16, s[16:19], s6 offen offset:3072 nt lds
    s_add_u32 m0, s7, 4096
    s_add_u32 s6, s6, s40
    buffer_load_dwordx4 v16, s[16:19], s8 offen offset:0 nt lds
    buffer_load_dwordx4 v16, s[16:19], s8 offen offset:1024 nt lds
    s_add_u32 m0, s7, 6144
    s_add_u32 s8, s8, s40
    buffer_load_dwordx4 v16, s[16:19], s6 offen offset:0 nt lds
    buffer_load_dwordx4 v16, s[16:19], s6 offen offset:1024 nt lds
    buffer_load_dwordx4 v16, s[16:19], s6 offen offset:2048 nt lds
    buffer_load_dwordx4 v16, s[16:19], s6 offen offset:3072 nt lds
    s_add_u32 m0, s7, 10240
    s_add_u32 s6, s6, s40
    buffer_load_dwordx4 v16, s[16:19], s8 offen offset:0 nt lds
    buffer_load_dwordx4 v16, s[16:19], s8 offen offset:1024 nt lds
    s_add_u32 m0, s7, 12288
    s_add_u32 s8, s8, s40
    s_cmp_eq_u32 s14, 2
    s_cbranch_scc1 L_cons2
    buffer_load_dwordx4 v16, s[16:19], s6 offen offset:0 nt lds
    buffer_load_dwordx4 v16, s[16:19], s6 offen offset:1024 nt lds
    buffer_load_dwordx4 v16, s[16:19], s6 offen offset:2048 nt lds
    buffer_load_dwordx4 v16, s[16:19], s6 offen offset:3072 nt lds
    s_add_u32 m0, s7, 16384
    s_add_u32 s6, s6, s40
    buffer_load_dwordx4 v16, s[16:19], s8 offen offset:0 nt lds
    buffer_load_dwordx4 v16, s[16:19], s8 offen offset:1024 nt lds
    s_branch L_cons2
L_spare:
    s_cmp_gt_u32 s14, 1
    s_cbranch_scc1 L_end
    s_cmp_gt_u32 s2, 27
    s_cbranch_scc1 L_end
    s_cmp_eq_u32 s2, 27
    s_cbranch_scc1 L_sp_nonce
    s_mul_i32 s28, s2, 57
    s_lshr_b32 s28, s28, 9
    s_mul_i32 s28, s28, 9
    s_sub_u32 s28, s2, s28
    s_mov_b32 s56, s8
    s_mov_b32 s57, s9
    s_mov_b32 s58, 36864
    s_mov_b32 s59, 0x20000
    v_and_b32 v3, 31, v1
    v_lshrrev_b32 v4, 5, v1
    v_mul_u32_u24 v6, 384, v3
    v_lshl_add_u32 v6, v4, 4, v6
    s_mul_i32 s29, s28, 11
    s_lshr_b32 s29, s29, 5
    s_mul_i32 s30, s29, 3
    s_sub_u32 s30, s28, s30
    s_cmp_eq_u32 s14, 1
    s_cbranch_scc1 L_sp_vo
    s_mov_b32 s52, s6
    s_mov_b32 s53, s7
    s_mov_b32 s54, 18432
    s_mov_b32 s55, 0x20000
    v_mul_u32_u24 v5, 192, v3
    v_lshl_add_u32 v5, v4, 4, v5
    s_mul_i32 s31, s29, 6144
    s_mul_i32 s32, s30, 12288

    buffer_load_dwordx4 v[8:11], v5, s[52:55], s31 offen offset:0
    buffer_load_dwordx4 v[32:35], v6, s[56:59], s32 offen offset:0
    buffer_load_dwordx4 v[12:15], v5, s[52:55], s31 offen offset:32
    buffer_load_dwordx4 v[36:39], v6, s[56:59], s32 offen offset:32
    buffer_load_dwordx4 v[16:19], v5, s[52:55], s31 offen offset:64
    buffer_load_dwordx4 v[40:43], v6, s[56:59], s32 offen offset:64
    buffer_load_dwordx4 v[20:23], v5, s[52:55], s31 offen offset:96
    buffer_load_dwordx4 v[44:47], v6, s[56:59], s32 offen offset:96
    buffer_load_dwordx4 v[24:27], v5, s[52:55], s31 offen offset:128
    buffer_load_dwordx4 v[48:51], v6, s[56:59], s32 offen offset:128
    buffer_load_dwordx4 v[28:31], v5, s[52:55], s31 offen offset:160
    buffer_load_dwordx4 v[52:55], v6, s[56:59], s32 offen offset:160
    v_lshlrev_b32 v7, 4, v3
    v_lshl_add_u32 v7, v4, 3, v7
    s_mul_i32 s33, s30, 6
    s_lshl_b32 s34, s29, 1
    s_add_u32 s33, s33, s34
    s_lshl_b32 s33, s33, 10
    s_add_u32 s33, s33, 182784
    s_mov_b32 s35, 0x3e16c740
    s_lshl_b32 s36, s28, 7
    s_add_u32 s36, s36, 332288

    s_waitcnt vmcnt(10)
    v_mfma_f32_32x32x16_bf16 v[64:79], v[8:11], v[32:35], 0
    s_waitcnt vmcnt(8)
    v_mfma_f32_32x32x16_bf16 v[64:79], v[12:15], v[36:39], v[64:79]
    s_waitcnt vmcnt(6)
    v_mfma_f32_32x32x16_bf16 v[64:79], v[16:19], v[40:43], v[64:79]
    s_waitcnt vmcnt(4)
    v_mfma_f32_32x32x16_bf16 v[64:79], v[20:23], v[44:47], v[64:79]
    s_waitcnt vmcnt(2)
    v_mfma_f32_32x32x16_bf16 v[64:79], v[24:27], v[48:51], v[64:79]
    s_waitcnt vmcnt(0)
    v_mfma_f32_32x32x16_bf16 v[64:79], v[28:31], v[52:55], v[64:79]
    s_nop 15
    v_mul_f32 v64, s35, v64
    v_mul_f32 v65, s35, v65
    v_mul_f32 v66, s35, v66
    v_mul_f32 v67, s35, v67
    v_mul_f32 v68, s35, v68
    v_mul_f32 v69, s35, v69
    v_mul_f32 v70, s35, v70
    v_mul_f32 v71, s35, v71
    v_mul_f32 v72, s35, v72
    v_mul_f32 v73, s35, v73
    v_mul_f32 v74, s35, v74
    v_mul_f32 v75, s35, v75
    v_mul_f32 v76, s35, v76
    v_mul_f32 v77, s35, v77
    v_mul_f32 v78, s35, v78
    v_mul_f32 v79, s35, v79
    v_cvt_pk_bf16_f32 v80, v64, v65
    v_cvt_pk_bf16_f32 v81, v66, v67
    v_cvt_pk_bf16_f32 v82, v68, v69
    v_cvt_pk_bf16_f32 v83, v70, v71
    v_cvt_pk_bf16_f32 v84, v72, v73
    v_cvt_pk_bf16_f32 v85, v74, v75
    v_cvt_pk_bf16_f32 v86, v76, v77
    v_cvt_pk_bf16_f32 v87, v78, v79
    buffer_store_dwordx2 v[80:81], v7, s[24:27], s33 offen offset:0 sc1
    buffer_store_dwordx2 v[82:83], v7, s[24:27], s33 offen offset:512 sc1
    buffer_store_dwordx2 v[84:85], v7, s[24:27], s33 offen offset:1024 sc1
    buffer_store_dwordx2 v[86:87], v7, s[24:27], s33 offen offset:1536 sc1
L_sp_flag:
    v_mov_b32 v24, 0
    s_mov_b32 s15, 0

L_sp_n:
    buffer_load_dwordx2 v[22:23], v24, s[48:51], 0 offen sc1
    s_waitcnt vmcnt(0)
    v_cmp_eq_u32 vcc, 0, v23
    s_cbranch_vccz L_sp_n_ok
    s_sleep 4
    s_add_u32 s15, s15, 1
    s_cmp_lt_u32 s15, 0x8000
    s_cbranch_scc1 L_sp_n
L_sp_n_ok:
    s_mov_b64 exec, 1
    buffer_store_dwordx2 v[22:23], v24, s[24:27], s36 offen sc1
    s_endpgm

L_sp_nonce:
    s_cmp_lg_u32 s14, 0
    s_cbranch_scc1 L_end
    s_memrealtime s[28:29]
    v_mov_b32 v4, 0
    s_waitcnt lgkmcnt(0)
    s_or_b32 s29, s29, 0x40000000
    v_mov_b32 v2, s28
    v_mov_b32 v3, s29
    s_mov_b64 exec, 1
    buffer_store_dwordx2 v[2:3], v4, s[48:51], 0 offen sc1
    s_mov_b32 exec_lo, 0xf8f8f8f0
    s_mov_b32 exec_hi, 0
    v_lshlrev_b32 v4, 4, v1
    s_mov_b32 s30, 204288
    buffer_store_dwordx2 v[2:3], v4, s[24:27], s30 offen sc1
    s_endpgm

L_x_w3:
    s_getpc_b64 s[58:59]
L_pc:
    s_sub_u32 s58, s58, L_pc-standalone__window_attn_twins__vision_kernel
    s_subb_u32 s59, s59, 0
    v_lshlrev_b32 v6, 7, v1
    v_min_u32 v7, L_end-standalone__window_attn_twins__vision_kernel, v6
    v_mov_b32 v5, s59
    v_add_co_u32 v4, vcc, s58, v7
    v_addc_co_u32 v5, vcc, 0, v5, vcc
    global_load_dword a252, v[4:5], off
    v_add_u32 v6, 0x2000, v6
    v_min_u32 v7, L_end-standalone__window_attn_twins__vision_kernel, v6
    v_mov_b32 v5, s59
    v_add_co_u32 v4, vcc, s58, v7
    v_addc_co_u32 v5, vcc, 0, v5, vcc
    global_load_dword a253, v[4:5], off
    v_add_u32 v6, 0x2000, v6
    v_min_u32 v7, L_end-standalone__window_attn_twins__vision_kernel, v6
    v_mov_b32 v5, s59
    v_add_co_u32 v4, vcc, s58, v7
    v_addc_co_u32 v5, vcc, 0, v5, vcc
    global_load_dword a254, v[4:5], off
    v_mov_b32 v2, 146688
    v_mov_b32 v4, 0
    v_mov_b32 v5, 0
    v_mov_b32 v6, 0
    v_mov_b32 v7, 0
    ds_write_b128 v2, v[4:7]
    s_waitcnt lgkmcnt(0)
L_cons2:
    s_barrier
    s_mul_i32 s53, s55, 7
    s_add_u32 s53, s53, s56
    s_mul_i32 s54, s14, 6528
    v_mov_b32 v24, 0
    v_mov_b32 v2, 146688
    s_mov_b32 s15, 0
    v_and_b32 v3, 31, v1
    v_lshrrev_b32 v4, 5, v1
    v_mul_u32_u24 v21, 192, v3
    v_lshl_add_u32 v21, v4, 4, v21
    s_mul_i32 s37, s14, s40
    s_add_u32 s37, s37, s39
    s_lshl_b32 s57, s40, 2
    s_add_u32 s38, s37, s57
    s_mov_b32 s20, s12
    s_mov_b32 s21, s13
    s_mov_b32 s22, 9633792
    s_mov_b32 s23, 0x20000
    s_mov_b32 s28, 0
    s_add_u32 s29, s54, 52224
    s_add_u32 s30, s54, 52224
    s_add_u32 s31, s54, 56576
    s_mov_b32 s33, 26112
    s_mov_b32 s34, 4294915072
    s_lshl_b32 s61, s14, 7
    s_add_u32 s61, s61, 204288
    s_sub_u32 s41, s61, 3072
    s_mul_i32 s57, s14, 6656
    s_add_u32 s57, s57, 115968
    v_mul_u32_u24 v28, 208, v3
    v_lshl_add_u32 v28, v4, 3, v28
    v_add_u32 v28, s57, v28

    v_add_u32 v5, 0, v1
    v_mul_u32_u24 v6, 171, v5
    v_lshrrev_b32 v6, 11, v6
    v_add_u32 v5, v5, v6
    v_lshlrev_b32 v5, 4, v5
    v_add_u32 v25, s57, v5
    v_add_u32 v5, 64, v1
    v_mul_u32_u24 v6, 171, v5
    v_lshrrev_b32 v6, 11, v6
    v_add_u32 v5, v5, v6
    v_lshlrev_b32 v5, 4, v5
    v_add_u32 v26, s57, v5
    v_add_u32 v5, 128, v1
    v_mul_u32_u24 v6, 171, v5
    v_lshrrev_b32 v6, 11, v6
    v_add_u32 v5, v5, v6
    v_lshlrev_b32 v5, 4, v5
    v_add_u32 v27, s57, v5
    v_lshrrev_b32 v9, 4, v1
    v_and_b32 v10, 15, v1
    v_lshrrev_b32 v6, 2, v10
    v_lshl_add_u32 v6, v9, 3, v6
    v_mul_u32_u24 v5, 192, v6
    v_and_b32 v8, 3, v1
    v_lshl_add_u32 v5, v8, 3, v5
    s_lshl_b32 s57, s14, 6
    s_add_u32 s57, s57, 78336
    v_add_u32 v5, s57, v5
    v_cmp_eq_u32 vcc, v9, v10
    v_mov_b32 v6, 0x3f803f80
    v_lshlrev_b32 v8, 4, v8
    v_cndmask_b32 v80, 0, v6, vcc
    v_cndmask_b32 v81, 0, v6, vcc
    v_cndmask_b32 v82, 0, v6, vcc
    v_cndmask_b32 v83, 0, v6, vcc
    v_lshl_add_u32 v8, v4, 6, v8
    v_add_u32 v8, 145920, v8
    v_and_b32 v3, 1, v9
    v_lshrrev_b32 v7, 1, v9
    v_lshlrev_b32 v29, 4, v10
    v_lshl_add_u32 v29, v7, 3, v29
    v_mul_u32_u24 v6, 1088, v3
    v_add_u32 v6, v6, v29
    v_lshl_add_u32 v29, v3, 6, v29
    s_lshl_b32 s57, s14, 8
    s_add_u32 s57, s57, 145920
    v_add_u32 v29, s57, v29
    s_lshr_b32 s57, s53, 3
    s_mul_i32 s57, s57, 6528
    s_and_b32 s58, s53, 7
    s_lshl_b32 s58, s58, 6
    s_add_u32 s59, s57, s58
    s_lshl_b32 s58, s14, 9
    s_mov_b32 s60, 2176
    s_cmp_eq_u32 s14, 2
    s_cselect_b32 s58, 4352, s58
    s_cselect_b32 s60, 512, s60
    s_add_u32 s59, s59, s58
    s_add_u32 s57, s59, s60
    s_mul_i32 s58, s14, 6144
    s_add_u32 s58, s58, 78336
    v_add_u32 v30, s58, v21
    v_add_u32 v31, s58, v16
    v_and_b32 v11, 7, v1
    v_lshlrev_b32 v11, 4, v11
    v_mov_b32 v3, 1

    v_mov_b32 v17, 0
    v_mov_b32 v18, 0
    v_mov_b32 v19, 0
    v_mov_b32 v20, 0
    v_mov_b32 v160, 0
    v_mov_b32 v161, 0
    v_mov_b32 v162, 0
    v_mov_b32 v163, 0
    v_mov_b32 v164, 0
    v_mov_b32 v165, 0
    v_mov_b32 v166, 0
    v_mov_b32 v167, 0
    v_mov_b32 v168, 0
    v_mov_b32 v169, 0
    v_mov_b32 v170, 0
    v_mov_b32 v171, 0
    v_mov_b32 v172, 0
    v_mov_b32 v173, 0
    v_mov_b32 v174, 0
    v_mov_b32 v175, 0
    v_mov_b32 v176, 0
    v_mov_b32 v177, 0
    v_mov_b32 v178, 0
    v_mov_b32 v179, 0
    v_mov_b32 v180, 0
    v_mov_b32 v181, 0
    v_mov_b32 v182, 0
    v_mov_b32 v183, 0
    v_mov_b32 v184, 0
    v_mov_b32 v185, 0
    v_mov_b32 v186, 0
    v_mov_b32 v187, 0
    v_mov_b32 v188, 0
    v_mov_b32 v189, 0
    v_mov_b32 v190, 0
    v_mov_b32 v191, 0
    v_mov_b32 v192, 0
    v_mov_b32 v193, 0
    v_mov_b32 v194, 0
    v_mov_b32 v195, 0
    v_mov_b32 v196, 0
    v_mov_b32 v197, 0
    v_mov_b32 v198, 0
    v_mov_b32 v199, 0
    v_mov_b32 v200, 0
    v_mov_b32 v201, 0
    v_mov_b32 v202, 0
    v_mov_b32 v203, 0
    v_mov_b32 v204, 0
    v_mov_b32 v205, 0
    v_mov_b32 v206, 0
    v_mov_b32 v207, 0
    v_mov_b32 v208, 0
    v_mov_b32 v209, 0
    v_mov_b32 v210, 0
    v_mov_b32 v211, 0
    v_mov_b32 v212, 0
    v_mov_b32 v213, 0
    v_mov_b32 v214, 0
    v_mov_b32 v215, 0
    v_mov_b32 v216, 0
    v_mov_b32 v217, 0
    v_mov_b32 v218, 0
    v_mov_b32 v219, 0
    v_mov_b32 v220, 0
    v_mov_b32 v221, 0
    v_mov_b32 v222, 0
    v_mov_b32 v223, 0
    v_mov_b32 v224, 0
    v_mov_b32 v225, 0
    v_mov_b32 v226, 0
    v_mov_b32 v227, 0
    v_mov_b32 v228, 0
    v_mov_b32 v229, 0
    v_mov_b32 v230, 0
    v_mov_b32 v231, 0
    v_mov_b32 v232, 0
    v_mov_b32 v233, 0
    v_mov_b32 v234, 0
    v_mov_b32 v235, 0
    v_mov_b32 v236, 0
    v_mov_b32 v237, 0
    v_mov_b32 v238, 0
    v_mov_b32 v239, 0
    v_mov_b32 v240, 0
    v_mov_b32 v241, 0
    v_mov_b32 v242, 0
    v_mov_b32 v243, 0
    v_mov_b32 v244, 0
    v_mov_b32 v245, 0
    v_mov_b32 v246, 0
    v_mov_b32 v247, 0
    v_mov_b32 v248, 0
    v_mov_b32 v249, 0
    v_mov_b32 v250, 0
    v_mov_b32 v251, 0
    v_mov_b32 v252, 0
    v_mov_b32 v253, 0
    v_mov_b32 v254, 0
    v_mov_b32 v255, 0
    s_cmp_eq_u32 s14, 3
    s_cbranch_scc1 L_x2
    s_cmp_lt_u32 s3, 120
    s_cbranch_scc1 L_x2
    s_mul_i32 s6, s14, 3
    s_mul_i32 s7, s6, 6144
    s_mul_i32 s6, s6, s40
    s_add_u32 s6, s6, s39
    s_add_u32 s7, s7, 78336
    s_mov_b32 m0, s7
    s_add_u32 s8, s6, 4096

    buffer_load_dwordx4 v16, s[16:19], s6 offen offset:0 nt lds
    buffer_load_dwordx4 v16, s[16:19], s6 offen offset:1024 nt lds
    buffer_load_dwordx4 v16, s[16:19], s6 offen offset:2048 nt lds
    buffer_load_dwordx4 v16, s[16:19], s6 offen offset:3072 nt lds
    s_add_u32 m0, s7, 4096
    s_add_u32 s6, s6, s40
    buffer_load_dwordx4 v16, s[16:19], s8 offen offset:0 nt lds
    buffer_load_dwordx4 v16, s[16:19], s8 offen offset:1024 nt lds
    s_add_u32 m0, s7, 6144
    s_add_u32 s8, s8, s40
    buffer_load_dwordx4 v16, s[16:19], s6 offen offset:0 nt lds
    buffer_load_dwordx4 v16, s[16:19], s6 offen offset:1024 nt lds
    buffer_load_dwordx4 v16, s[16:19], s6 offen offset:2048 nt lds
    buffer_load_dwordx4 v16, s[16:19], s6 offen offset:3072 nt lds
    s_add_u32 m0, s7, 10240
    s_add_u32 s6, s6, s40
    buffer_load_dwordx4 v16, s[16:19], s8 offen offset:0 nt lds
    buffer_load_dwordx4 v16, s[16:19], s8 offen offset:1024 nt lds
    s_add_u32 m0, s7, 12288
    s_add_u32 s8, s8, s40
    s_cmp_eq_u32 s14, 2
    s_cbranch_scc1 L_x2
    buffer_load_dwordx4 v16, s[16:19], s6 offen offset:0 nt lds
    buffer_load_dwordx4 v16, s[16:19], s6 offen offset:1024 nt lds
    buffer_load_dwordx4 v16, s[16:19], s6 offen offset:2048 nt lds
    buffer_load_dwordx4 v16, s[16:19], s6 offen offset:3072 nt lds
    s_add_u32 m0, s7, 16384
    s_add_u32 s6, s6, s40
    buffer_load_dwordx4 v16, s[16:19], s8 offen offset:0 nt lds
    buffer_load_dwordx4 v16, s[16:19], s8 offen offset:1024 nt lds
L_x2:
    s_cmp_eq_u32 s14, 3
    s_cbranch_scc1 L_w3
    buffer_load_dword a240, v24, s[20:23], s37 offen
    buffer_load_dword a241, v24, s[20:23], s38 offen
    buffer_load_dwordx2 v[22:23], v24, s[48:51], 0 offen sc1
    s_waitcnt vmcnt(3)
    s_mov_b64 exec, 1
    ds_add_u32 v2, v3
    s_mov_b64 exec, -1
L_xw:
    ds_read_b32 v4, v2
    s_waitcnt lgkmcnt(0)
    v_cmp_ne_u32 vcc, 3, v4
    s_cbranch_vccnz L_xw
    ds_read_b64_tr_b16 v[96:97], v5 offset:0
    ds_read_b64_tr_b16 v[98:99], v5 offset:768
    ds_read_b64_tr_b16 v[100:101], v5 offset:32
    ds_read_b64_tr_b16 v[102:103], v5 offset:800
    ds_read_b64_tr_b16 v[104:105], v5 offset:6144
    ds_read_b64_tr_b16 v[106:107], v5 offset:6912
    ds_read_b64_tr_b16 v[108:109], v5 offset:6176
    ds_read_b64_tr_b16 v[110:111], v5 offset:6944
    ds_read_b64_tr_b16 v[112:113], v5 offset:12288
    ds_read_b64_tr_b16 v[114:115], v5 offset:13056
    ds_read_b64_tr_b16 v[116:117], v5 offset:12320
    ds_read_b64_tr_b16 v[118:119], v5 offset:13088
    s_waitcnt lgkmcnt(8)
    v_mfma_f32_16x16x32_bf16 v[32:35], v[96:99], v[80:83], 0
    v_mfma_f32_16x16x32_bf16 v[36:39], v[100:103], v[80:83], 0
    ds_read_b64_tr_b16 v[120:121], v5 offset:18432
    ds_read_b64_tr_b16 v[122:123], v5 offset:19200
    ds_read_b64_tr_b16 v[124:125], v5 offset:18464
    ds_read_b64_tr_b16 v[126:127], v5 offset:19232
    s_waitcnt lgkmcnt(8)
    v_mfma_f32_16x16x32_bf16 v[40:43], v[104:107], v[80:83], 0
    v_mfma_f32_16x16x32_bf16 v[44:47], v[108:111], v[80:83], 0
    ds_read_b64_tr_b16 v[128:129], v5 offset:24576
    ds_read_b64_tr_b16 v[130:131], v5 offset:25344
    ds_read_b64_tr_b16 v[132:133], v5 offset:24608
    ds_read_b64_tr_b16 v[134:135], v5 offset:25376
    s_waitcnt lgkmcnt(8)
    v_mfma_f32_16x16x32_bf16 v[32:35], v[112:115], v[80:83], v[32:35]
    v_mfma_f32_16x16x32_bf16 v[36:39], v[116:119], v[80:83], v[36:39]
    ds_read_b64_tr_b16 v[136:137], v5 offset:30720
    ds_read_b64_tr_b16 v[138:139], v5 offset:31488
    ds_read_b64_tr_b16 v[140:141], v5 offset:30752
    ds_read_b64_tr_b16 v[142:143], v5 offset:31520
    s_waitcnt lgkmcnt(8)
    v_mfma_f32_16x16x32_bf16 v[40:43], v[120:123], v[80:83], v[40:43]
    v_mfma_f32_16x16x32_bf16 v[44:47], v[124:127], v[80:83], v[44:47]
    ds_read_b64_tr_b16 v[144:145], v5 offset:36864
    ds_read_b64_tr_b16 v[146:147], v5 offset:37632
    ds_read_b64_tr_b16 v[148:149], v5 offset:36896
    ds_read_b64_tr_b16 v[150:151], v5 offset:37664
    s_waitcnt lgkmcnt(8)
    v_mfma_f32_16x16x32_bf16 v[32:35], v[128:131], v[80:83], v[32:35]
    v_mfma_f32_16x16x32_bf16 v[36:39], v[132:135], v[80:83], v[36:39]
    ds_read_b64_tr_b16 v[152:153], v5 offset:43008
    ds_read_b64_tr_b16 v[154:155], v5 offset:43776
    ds_read_b64_tr_b16 v[156:157], v5 offset:43040
    ds_read_b64_tr_b16 v[158:159], v5 offset:43808
    s_waitcnt lgkmcnt(8)
    v_mfma_f32_16x16x32_bf16 v[40:43], v[136:139], v[80:83], v[40:43]
    v_mfma_f32_16x16x32_bf16 v[44:47], v[140:143], v[80:83], v[44:47]
    s_waitcnt lgkmcnt(4)
    v_mfma_f32_16x16x32_bf16 v[32:35], v[144:147], v[80:83], v[32:35]
    v_mfma_f32_16x16x32_bf16 v[36:39], v[148:151], v[80:83], v[36:39]
    s_waitcnt lgkmcnt(0)
    v_mfma_f32_16x16x32_bf16 v[40:43], v[152:155], v[80:83], v[40:43]
    v_mfma_f32_16x16x32_bf16 v[44:47], v[156:159], v[80:83], v[44:47]
    s_mov_b32 s60, 0x3c800000
    v_cmp_gt_u32 vcc, 4, v10
    ds_read_b128 a[144:147], v30 offset:0
    ds_read_b128 a[148:151], v30 offset:32
    ds_read_b128 a[152:155], v30 offset:64
    ds_read_b128 a[156:159], v30 offset:96
    ds_read_b128 a[160:163], v30 offset:128
    ds_read_b128 a[164:167], v30 offset:160
    ds_read_b128 a[168:171], v30 offset:24576
    ds_read_b128 a[172:175], v30 offset:24608
    ds_read_b128 a[176:179], v30 offset:24640
    ds_read_b128 a[180:183], v30 offset:24672
    ds_read_b128 a[184:187], v30 offset:24704
    ds_read_b128 a[188:191], v30 offset:24736
    v_add_f32 v32, v32, v40
    v_add_f32 v33, v33, v41
    v_add_f32 v34, v34, v42
    v_add_f32 v35, v35, v43
    v_add_f32 v36, v36, v44
    v_add_f32 v37, v37, v45
    v_add_f32 v38, v38, v46
    v_add_f32 v39, v39, v47
    v_mul_f32 v32, s60, v32
    v_mul_f32 v33, s60, v33
    v_mul_f32 v34, s60, v34
    v_mul_f32 v35, s60, v35
    v_mul_f32 v36, s60, v36
    v_mul_f32 v37, s60, v37
    v_mul_f32 v38, s60, v38
    v_mul_f32 v39, s60, v39
    v_cvt_pk_bf16_f32 v48, v32, v33
    v_cvt_pk_bf16_f32 v49, v34, v35
    v_cvt_pk_bf16_f32 v50, v36, v37
    v_cvt_pk_bf16_f32 v51, v38, v39
    s_cmp_eq_u32 s56, 7
    s_mov_b64 exec, vcc
    s_cbranch_scc1 L_nostore
    buffer_store_dwordx2 v[48:49], v6, s[24:27], s59 offen sc1
    buffer_store_dwordx2 v[50:51], v6, s[24:27], s57 offen sc1
L_nostore:
    ds_write_b64 v29, v[48:49] offset:0
    ds_write_b64 v29, v[50:51] offset:128
    s_mov_b64 exec, -1
    s_cbranch_scc1 L_nw0
    s_waitcnt vmcnt(2)
    s_branch L_nw1
L_nw0:
    s_waitcnt vmcnt(0)
L_nw1:
    v_cmp_eq_u32 vcc, 0, v23
    s_cbranch_vccz L_nonce_ok
L_nonce:
    buffer_load_dwordx2 v[22:23], v24, s[48:51], 0 offen sc1
    s_waitcnt vmcnt(0)
    v_cmp_eq_u32 vcc, 0, v23
    s_cbranch_vccz L_nonce_ok
    s_sleep 4
    s_add_u32 s15, s15, 1
    s_cmp_lt_u32 s15, 0x8000
    s_cbranch_scc1 L_nonce
L_nonce_ok:
    v_readfirstlane_b32 s4, v22
    v_readfirstlane_b32 s5, v23
    s_waitcnt lgkmcnt(0)
    s_mov_b64 exec, 1
    ds_add_u32 v2, v3 offset:4
    s_mov_b64 exec, -1
    s_mov_b32 s59, 0
    s_mov_b32 s55, 0

    s_mov_b32 s57, 0
L_pq:
    ds_read2_b32 v[4:5], v2 offset0:1 offset1:2
    s_waitcnt lgkmcnt(0)
    v_add_u32 v4, v4, v5
    v_cmp_ne_u32 vcc, 4, v4
    s_cbranch_vccz L_q
    s_add_u32 s57, s57, 1
    s_cmp_lt_u32 s57, 5
    s_cbranch_scc1 L_pq
    s_lshl_b32 s60, s53, 4
    s_add_u32 s60, s60, 201216
    v_mov_b32 v6, s4
    v_mov_b32 v7, s5
    s_waitcnt vmcnt(0)
    s_mov_b64 exec, 1
    ds_add_rtn_u32 v5, v2, v3 offset:12
    s_waitcnt lgkmcnt(0)
    v_cmp_eq_u32 vcc, 2, v5
    s_cmp_eq_u32 s56, 7
    s_cbranch_scc1 L_noflaga
    s_cbranch_vccz L_noflaga
    buffer_store_dwordx2 v[6:7], v24, s[24:27], s60 offen sc1

L_noflaga:
    s_mov_b64 exec, -1
    s_mov_b32 s59, 1
L_pw:
    s_mov_b32 s57, 0
L_pw1:
    ds_read2_b32 v[4:5], v2 offset0:1 offset1:2
    s_waitcnt lgkmcnt(0)
    v_add_u32 v4, v4, v5
    v_cmp_ne_u32 vcc, 4, v4
    s_cbranch_vccz L_q
    s_add_u32 s57, s57, 1
    s_cmp_lt_u32 s57, 64
    s_cbranch_scc1 L_pw1
    s_branch L_pw
L_w3:
    buffer_load_dword a240, v24, s[20:23], s37 offen
    v_accvgpr_write_b32 a0, 0
    v_accvgpr_write_b32 a1, 0
    v_accvgpr_write_b32 a2, 0
    v_accvgpr_write_b32 a3, 0
    v_accvgpr_write_b32 a4, 0
    v_accvgpr_write_b32 a5, 0
    v_accvgpr_write_b32 a6, 0
    v_accvgpr_write_b32 a7, 0
    v_accvgpr_write_b32 a8, 0
    v_accvgpr_write_b32 a9, 0
    v_accvgpr_write_b32 a10, 0
    v_accvgpr_write_b32 a11, 0
    v_accvgpr_write_b32 a12, 0
    v_accvgpr_write_b32 a13, 0
    v_accvgpr_write_b32 a14, 0
    v_accvgpr_write_b32 a15, 0
    v_accvgpr_write_b32 a16, 0
    v_accvgpr_write_b32 a17, 0
    v_accvgpr_write_b32 a18, 0
    v_accvgpr_write_b32 a19, 0
    v_accvgpr_write_b32 a20, 0
    v_accvgpr_write_b32 a21, 0
    v_accvgpr_write_b32 a22, 0
    v_accvgpr_write_b32 a23, 0
    v_accvgpr_write_b32 a24, 0
    v_accvgpr_write_b32 a25, 0
    v_accvgpr_write_b32 a26, 0
    v_accvgpr_write_b32 a27, 0
    v_accvgpr_write_b32 a28, 0
    v_accvgpr_write_b32 a29, 0
    v_accvgpr_write_b32 a30, 0
    v_accvgpr_write_b32 a31, 0
    v_accvgpr_write_b32 a32, 0
    v_accvgpr_write_b32 a33, 0
    v_accvgpr_write_b32 a34, 0
    v_accvgpr_write_b32 a35, 0
    v_accvgpr_write_b32 a36, 0
    v_accvgpr_write_b32 a37, 0
    v_accvgpr_write_b32 a38, 0
    v_accvgpr_write_b32 a39, 0
    v_accvgpr_write_b32 a40, 0
    v_accvgpr_write_b32 a41, 0
    v_accvgpr_write_b32 a42, 0
    v_accvgpr_write_b32 a43, 0
    v_accvgpr_write_b32 a44, 0
    v_accvgpr_write_b32 a45, 0
    v_accvgpr_write_b32 a46, 0
    v_accvgpr_write_b32 a47, 0
    v_accvgpr_write_b32 a48, 0
    v_accvgpr_write_b32 a49, 0
    v_accvgpr_write_b32 a50, 0
    v_accvgpr_write_b32 a51, 0
    v_accvgpr_write_b32 a52, 0
    v_accvgpr_write_b32 a53, 0
    v_accvgpr_write_b32 a54, 0
    v_accvgpr_write_b32 a55, 0
    v_accvgpr_write_b32 a56, 0
    v_accvgpr_write_b32 a57, 0
    v_accvgpr_write_b32 a58, 0
    v_accvgpr_write_b32 a59, 0
    v_accvgpr_write_b32 a60, 0
    v_accvgpr_write_b32 a61, 0
    v_accvgpr_write_b32 a62, 0
    v_accvgpr_write_b32 a63, 0
    v_accvgpr_write_b32 a64, 0
    v_accvgpr_write_b32 a65, 0
    v_accvgpr_write_b32 a66, 0
    v_accvgpr_write_b32 a67, 0
    v_accvgpr_write_b32 a68, 0
    v_accvgpr_write_b32 a69, 0
    v_accvgpr_write_b32 a70, 0
    v_accvgpr_write_b32 a71, 0
    v_accvgpr_write_b32 a72, 0
    v_accvgpr_write_b32 a73, 0
    v_accvgpr_write_b32 a74, 0
    v_accvgpr_write_b32 a75, 0
    v_accvgpr_write_b32 a76, 0
    v_accvgpr_write_b32 a77, 0
    v_accvgpr_write_b32 a78, 0
    v_accvgpr_write_b32 a79, 0
    v_accvgpr_write_b32 a80, 0
    v_accvgpr_write_b32 a81, 0
    v_accvgpr_write_b32 a82, 0
    v_accvgpr_write_b32 a83, 0
    v_accvgpr_write_b32 a84, 0
    v_accvgpr_write_b32 a85, 0
    v_accvgpr_write_b32 a86, 0
    v_accvgpr_write_b32 a87, 0
    v_accvgpr_write_b32 a88, 0
    v_accvgpr_write_b32 a89, 0
    v_accvgpr_write_b32 a90, 0
    v_accvgpr_write_b32 a91, 0
    v_accvgpr_write_b32 a92, 0
    v_accvgpr_write_b32 a93, 0
    v_accvgpr_write_b32 a94, 0
    v_accvgpr_write_b32 a95, 0
    v_min_u32 v4, 8, v1
    v_lshlrev_b32 v4, 7, v4
    s_mov_b32 s57, 332288
L_wq:
    buffer_load_dwordx2 v[6:7], v24, s[48:51], 0 offen sc1
    buffer_load_dwordx2 v[22:23], v4, s[24:27], s57 offen sc1
    s_waitcnt vmcnt(0)
    v_cmp_eq_u32 s[58:59], 0, v7
    v_cmp_ne_u64 vcc, v[6:7], v[22:23]
    s_or_b64 vcc, vcc, s[58:59]
    s_cbranch_vccz L_wq_ok
    s_sleep 4
    s_add_u32 s15, s15, 1
    s_cmp_lt_u32 s15, 0x8000
    s_cbranch_scc1 L_wq
L_wq_ok:
    v_readfirstlane_b32 s4, v6
    v_readfirstlane_b32 s5, v7
    s_mov_b32 s57, 182784
    s_mov_b32 s58, 127488
    s_mov_b32 m0, s58
    s_add_u32 s58, s58, 4096
    buffer_load_dwordx4 v16, s[24:27], s57 offen offset:0 sc1 lds
    buffer_load_dwordx4 v16, s[24:27], s57 offen offset:1024 sc1 lds
    buffer_load_dwordx4 v16, s[24:27], s57 offen offset:2048 sc1 lds
    buffer_load_dwordx4 v16, s[24:27], s57 offen offset:3072 sc1 lds
    s_add_u32 s57, s57, 4096
    s_mov_b32 m0, s58
    s_add_u32 s58, s58, 4096
    buffer_load_dwordx4 v16, s[24:27], s57 offen offset:0 sc1 lds
    buffer_load_dwordx4 v16, s[24:27], s57 offen offset:1024 sc1 lds
    buffer_load_dwordx4 v16, s[24:27], s57 offen offset:2048 sc1 lds
    buffer_load_dwordx4 v16, s[24:27], s57 offen offset:3072 sc1 lds
    s_add_u32 s57, s57, 4096
    s_mov_b32 m0, s58
    s_add_u32 s58, s58, 4096
    buffer_load_dwordx4 v16, s[24:27], s57 offen offset:0 sc1 lds
    buffer_load_dwordx4 v16, s[24:27], s57 offen offset:1024 sc1 lds
    buffer_load_dwordx4 v16, s[24:27], s57 offen offset:2048 sc1 lds
    buffer_load_dwordx4 v16, s[24:27], s57 offen offset:3072 sc1 lds
    s_add_u32 s57, s57, 4096
    s_mov_b32 m0, s58
    s_add_u32 s58, s58, 4096
    buffer_load_dwordx4 v16, s[24:27], s57 offen offset:0 sc1 lds
    buffer_load_dwordx4 v16, s[24:27], s57 offen offset:1024 sc1 lds
    buffer_load_dwordx4 v16, s[24:27], s57 offen offset:2048 sc1 lds
    buffer_load_dwordx4 v16, s[24:27], s57 offen offset:3072 sc1 lds
    s_add_u32 s57, s57, 4096
    s_mov_b32 m0, s58
    s_add_u32 s58, s58, 4096
    buffer_load_dwordx4 v16, s[24:27], s57 offen offset:0 sc1 lds
    buffer_load_dwordx4 v16, s[24:27], s57 offen offset:1024 sc1 lds
    s_add_u32 s57, s57, 4096
L_w3x:
    ds_read_b32 v4, v2
    s_waitcnt lgkmcnt(0)
    v_cmp_ne_u32 vcc, 3, v4
    s_cbranch_vccnz L_w3x
    ds_read_b128 a[144:147], v30 offset:0
    ds_read_b128 a[148:151], v30 offset:32
    ds_read_b128 a[152:155], v30 offset:64
    ds_read_b128 a[156:159], v30 offset:96
    ds_read_b128 a[160:163], v30 offset:128
    ds_read_b128 a[164:167], v30 offset:160
    s_waitcnt vmcnt(0) lgkmcnt(0)
    ds_write_b32 v2, v3 offset:8
    v_lshlrev_b32 v0, 4, v1
    s_mov_b32 s57, 201216
L_w3p:
    ds_read_b32 v4, v2 offset:4
    s_waitcnt lgkmcnt(0)
    v_cmp_ne_u32 vcc, 3, v4
    s_cbranch_vccnz L_w3p
    s_branch L_q3
L_q:
    v_add_u32 v4, 127488, v16
    ds_read_b128 v[96:99], v4 offset:0
    ds_read_b128 v[100:103], v4 offset:1024
    ds_read_b128 v[104:107], v4 offset:2048
    ds_read_b128 v[108:111], v4 offset:3072
    ds_read_b128 v[112:115], v4 offset:4096
    ds_read_b128 v[116:119], v4 offset:5120
    ds_read_b128 v[120:123], v4 offset:6144
    ds_read_b128 v[124:127], v4 offset:7168
    ds_read_b128 v[128:131], v4 offset:8192
    ds_read_b128 v[132:135], v4 offset:9216
    ds_read_b128 v[136:139], v4 offset:10240
    ds_read_b128 v[140:143], v4 offset:11264
    ds_read_b128 v[144:147], v4 offset:12288
    ds_read_b128 v[148:151], v4 offset:13312
    ds_read_b128 v[152:155], v4 offset:14336
    ds_read_b128 v[156:159], v4 offset:15360
    ds_read_b128 a[244:247], v4 offset:16384
    ds_read_b128 a[248:251], v4 offset:17408
    ds_read_b128 a[216:219], v8 offset:0
    ds_read_b128 a[220:223], v8 offset:128
    ds_read_b128 a[224:227], v8 offset:256
    ds_read_b128 a[228:231], v8 offset:384
    ds_read_b128 a[232:235], v8 offset:512
    ds_read_b128 a[236:239], v8 offset:640
    s_waitcnt lgkmcnt(15)
    v_mfma_f32_32x32x16_bf16 v[32:47], v[96:99], a[144:147], 0
    v_mfma_f32_32x32x16_bf16 v[32:47], v[100:103], a[148:151], v[32:47]
    v_mfma_f32_32x32x16_bf16 v[32:47], v[104:107], a[152:155], v[32:47]
    v_mfma_f32_32x32x16_bf16 v[32:47], v[108:111], a[156:159], v[32:47]
    v_mfma_f32_32x32x16_bf16 v[32:47], v[112:115], a[160:163], v[32:47]
    v_mfma_f32_32x32x16_bf16 v[32:47], v[116:119], a[164:167], v[32:47]
    s_waitcnt lgkmcnt(12)
    v_mfma_f32_32x32x16_bf16 v[48:63], v[120:123], a[144:147], 0
    v_mfma_f32_32x32x16_bf16 v[48:63], v[124:127], a[148:151], v[48:63]
    v_mfma_f32_32x32x16_bf16 v[48:63], v[128:131], a[152:155], v[48:63]
    v_cvt_pk_bf16_f32 v32, v32, v33
    v_cvt_pk_bf16_f32 v33, v34, v35
    v_cvt_pk_bf16_f32 v34, v36, v37
    v_cvt_pk_bf16_f32 v35, v38, v39
    v_cvt_pk_bf16_f32 v36, v40, v41
    v_cvt_pk_bf16_f32 v37, v42, v43
    v_mfma_f32_32x32x16_bf16 v[48:63], v[132:135], a[156:159], v[48:63]
    v_cvt_pk_bf16_f32 v38, v44, v45
    v_cvt_pk_bf16_f32 v39, v46, v47
    v_accvgpr_write_b32 a96, v32
    v_accvgpr_write_b32 a97, v33
    v_accvgpr_write_b32 a98, v34
    v_accvgpr_write_b32 a99, v35
    v_mfma_f32_32x32x16_bf16 v[48:63], v[136:139], a[160:163], v[48:63]
    v_accvgpr_write_b32 a100, v36
    v_accvgpr_write_b32 a101, v37
    v_accvgpr_write_b32 a102, v38
    v_accvgpr_write_b32 a103, v39
    v_mfma_f32_32x32x16_bf16 v[48:63], v[140:143], a[164:167], v[48:63]
    s_cmp_eq_u32 s59, 1
    s_cbranch_scc1 L_pub_done
    s_lshl_b32 s60, s53, 4
    s_add_u32 s60, s60, 201216
    v_mov_b32 v6, s4
    v_mov_b32 v7, s5
    s_waitcnt vmcnt(0)
    s_mov_b64 exec, 1
    ds_add_rtn_u32 v5, v2, v3 offset:12
    s_waitcnt lgkmcnt(0)
    v_cmp_eq_u32 vcc, 2, v5
    s_cmp_eq_u32 s56, 7
    s_cbranch_scc1 L_noflagb
    s_cbranch_vccz L_noflagb
    buffer_store_dwordx2 v[6:7], v24, s[24:27], s60 offen sc1

L_noflagb:
    s_mov_b64 exec, -1
    s_mov_b32 s59, 1
L_pub_done:
    s_lshl_b32 s60, s14, 10
    s_add_u32 s60, s60, 102912
    v_add_u32 v3, s60, v16
    s_waitcnt lgkmcnt(6)
    v_mfma_f32_32x32x16_bf16 v[64:79], v[144:147], a[144:147], 0
    v_mfma_f32_32x32x16_bf16 v[64:79], v[148:151], a[148:151], v[64:79]
    v_mfma_f32_32x32x16_bf16 v[64:79], v[152:155], a[152:155], v[64:79]
    v_cvt_pk_bf16_f32 v48, v48, v49
    v_cvt_pk_bf16_f32 v49, v50, v51
    v_cvt_pk_bf16_f32 v50, v52, v53
    v_cvt_pk_bf16_f32 v51, v54, v55
    v_cvt_pk_bf16_f32 v52, v56, v57
    v_cvt_pk_bf16_f32 v53, v58, v59
    v_mfma_f32_32x32x16_bf16 v[64:79], v[156:159], a[156:159], v[64:79]
    v_cvt_pk_bf16_f32 v54, v60, v61
    v_cvt_pk_bf16_f32 v55, v62, v63
    v_accvgpr_write_b32 a104, v48
    v_accvgpr_write_b32 a105, v49
    v_accvgpr_write_b32 a106, v50
    v_accvgpr_write_b32 a107, v51
    v_mfma_f32_32x32x16_bf16 v[64:79], a[244:247], a[160:163], v[64:79]
    v_accvgpr_write_b32 a108, v52
    v_accvgpr_write_b32 a109, v53
    v_accvgpr_write_b32 a110, v54
    v_accvgpr_write_b32 a111, v55
    v_mfma_f32_32x32x16_bf16 v[64:79], a[248:251], a[164:167], v[64:79]
    s_waitcnt lgkmcnt(0)
    v_mfma_f32_32x32x16_bf16 v[80:95], v[96:99], a[168:171], 0
    v_mfma_f32_32x32x16_bf16 v[80:95], v[100:103], a[172:175], v[80:95]
    v_mfma_f32_32x32x16_bf16 v[80:95], v[104:107], a[176:179], v[80:95]
    v_cvt_pk_bf16_f32 v64, v64, v65
    v_cvt_pk_bf16_f32 v65, v66, v67
    v_cvt_pk_bf16_f32 v66, v68, v69
    v_cvt_pk_bf16_f32 v67, v70, v71
    v_cvt_pk_bf16_f32 v68, v72, v73
    v_cvt_pk_bf16_f32 v69, v74, v75
    v_mfma_f32_32x32x16_bf16 v[80:95], v[108:111], a[180:183], v[80:95]
    v_cvt_pk_bf16_f32 v70, v76, v77
    v_cvt_pk_bf16_f32 v71, v78, v79
    v_accvgpr_write_b32 a112, v64
    v_accvgpr_write_b32 a113, v65
    v_accvgpr_write_b32 a114, v66
    v_accvgpr_write_b32 a115, v67
    v_mfma_f32_32x32x16_bf16 v[80:95], v[112:115], a[184:187], v[80:95]
    v_accvgpr_write_b32 a116, v68
    v_accvgpr_write_b32 a117, v69
    v_accvgpr_write_b32 a118, v70
    v_accvgpr_write_b32 a119, v71
    v_mfma_f32_32x32x16_bf16 v[80:95], v[116:119], a[188:191], v[80:95]
    v_mfma_f32_32x32x16_bf16 v[32:47], v[120:123], a[168:171], 0
    v_mfma_f32_32x32x16_bf16 v[32:47], v[124:127], a[172:175], v[32:47]
    v_mfma_f32_32x32x16_bf16 v[32:47], v[128:131], a[176:179], v[32:47]
    v_cvt_pk_bf16_f32 v80, v80, v81
    v_cvt_pk_bf16_f32 v81, v82, v83
    v_cvt_pk_bf16_f32 v82, v84, v85
    v_cvt_pk_bf16_f32 v83, v86, v87
    v_cvt_pk_bf16_f32 v84, v88, v89
    v_cvt_pk_bf16_f32 v85, v90, v91
    v_mfma_f32_32x32x16_bf16 v[32:47], v[132:135], a[180:183], v[32:47]
    v_cvt_pk_bf16_f32 v86, v92, v93
    v_cvt_pk_bf16_f32 v87, v94, v95
    v_accvgpr_write_b32 a120, v80
    v_accvgpr_write_b32 a121, v81
    v_accvgpr_write_b32 a122, v82
    v_accvgpr_write_b32 a123, v83
    v_mfma_f32_32x32x16_bf16 v[32:47], v[136:139], a[184:187], v[32:47]
    v_accvgpr_write_b32 a124, v84
    v_accvgpr_write_b32 a125, v85
    v_accvgpr_write_b32 a126, v86
    v_accvgpr_write_b32 a127, v87
    v_mfma_f32_32x32x16_bf16 v[32:47], v[140:143], a[188:191], v[32:47]
    ds_write_b128 v31, v[80:83] offset:0
    ds_write_b128 v31, v[84:87] offset:1024
    v_mfma_f32_32x32x16_bf16 v[48:63], v[144:147], a[168:171], 0
    v_mfma_f32_32x32x16_bf16 v[48:63], v[148:151], a[172:175], v[48:63]
    v_mfma_f32_32x32x16_bf16 v[48:63], v[152:155], a[176:179], v[48:63]
    v_cvt_pk_bf16_f32 v32, v32, v33
    v_cvt_pk_bf16_f32 v33, v34, v35
    v_cvt_pk_bf16_f32 v34, v36, v37
    v_cvt_pk_bf16_f32 v35, v38, v39
    v_cvt_pk_bf16_f32 v36, v40, v41
    v_cvt_pk_bf16_f32 v37, v42, v43
    v_mfma_f32_32x32x16_bf16 v[48:63], v[156:159], a[180:183], v[48:63]
    v_cvt_pk_bf16_f32 v38, v44, v45
    v_cvt_pk_bf16_f32 v39, v46, v47
    v_accvgpr_write_b32 a128, v32
    v_accvgpr_write_b32 a129, v33
    v_accvgpr_write_b32 a130, v34
    v_accvgpr_write_b32 a131, v35
    v_mfma_f32_32x32x16_bf16 v[48:63], a[244:247], a[184:187], v[48:63]
    v_accvgpr_write_b32 a132, v36
    v_accvgpr_write_b32 a133, v37
    v_accvgpr_write_b32 a134, v38
    v_accvgpr_write_b32 a135, v39
    v_mfma_f32_32x32x16_bf16 v[48:63], a[248:251], a[188:191], v[48:63]
    ds_write_b128 v31, v[32:35] offset:2048
    ds_write_b128 v31, v[36:39] offset:3072
    v_mfma_f32_32x32x16_bf16 v[64:79], a[216:219], a[96:99], 0
    v_mfma_f32_32x32x16_bf16 v[64:79], a[220:223], a[100:103], v[64:79]
    v_mfma_f32_32x32x16_bf16 v[64:79], a[224:227], a[104:107], v[64:79]
    v_cvt_pk_bf16_f32 v48, v48, v49
    v_cvt_pk_bf16_f32 v49, v50, v51
    v_cvt_pk_bf16_f32 v50, v52, v53
    v_cvt_pk_bf16_f32 v51, v54, v55
    v_cvt_pk_bf16_f32 v52, v56, v57
    v_cvt_pk_bf16_f32 v53, v58, v59
    v_mfma_f32_32x32x16_bf16 v[64:79], a[228:231], a[108:111], v[64:79]
    v_cvt_pk_bf16_f32 v54, v60, v61
    v_cvt_pk_bf16_f32 v55, v62, v63
    v_accvgpr_write_b32 a136, v48
    v_accvgpr_write_b32 a137, v49
    v_accvgpr_write_b32 a138, v50
    v_accvgpr_write_b32 a139, v51
    v_mfma_f32_32x32x16_bf16 v[64:79], a[232:235], a[112:115], v[64:79]
    v_accvgpr_write_b32 a140, v52
    v_accvgpr_write_b32 a141, v53
    v_accvgpr_write_b32 a142, v54
    v_accvgpr_write_b32 a143, v55
    v_mfma_f32_32x32x16_bf16 v[64:79], a[236:239], a[116:119], v[64:79]
    ds_write_b128 v31, v[48:51] offset:4096
    ds_write_b128 v31, v[52:55] offset:5120
    v_mfma_f32_32x32x16_bf16 v[80:95], a[216:219], a[120:123], 0
    v_mfma_f32_32x32x16_bf16 v[80:95], a[220:223], a[124:127], v[80:95]
    v_mfma_f32_32x32x16_bf16 v[80:95], a[224:227], a[128:131], v[80:95]
    v_max3_f32 v9, v64, v65, v66
    v_max_f32 v9, v9, v67
    v_sub_f32 v96, 0, v9
    v_sub_f32 v97, 0, v9
    v_sub_f32 v98, 0, v9
    v_sub_f32 v99, 0, v9
    v_mfma_f32_32x32x16_bf16 v[80:95], a[228:231], a[132:135], v[80:95]
    v_sub_f32 v100, 0, v9
    v_sub_f32 v101, 0, v9
    v_sub_f32 v102, 0, v9
    v_sub_f32 v103, 0, v9
    v_sub_f32 v104, 0, v9
    v_sub_f32 v105, 0, v9
    v_mfma_f32_32x32x16_bf16 v[80:95], a[232:235], a[136:139], v[80:95]
    v_sub_f32 v106, 0, v9
    v_sub_f32 v107, 0, v9
    v_sub_f32 v108, 0, v9
    v_sub_f32 v109, 0, v9
    v_sub_f32 v110, 0, v9
    v_sub_f32 v111, 0, v9
    v_mfma_f32_32x32x16_bf16 v[80:95], a[236:239], a[140:143], v[80:95]
    v_lshrrev_b32 v21, 5, v1
    v_mul_u32_u24 v15, 1088, v21
    v_and_b32 v31, 31, v1
    v_lshl_add_u32 v15, v31, 4, v15
    v_bfe_u32 v31, v1, 2, 2
    v_lshl_add_u32 v31, v21, 2, v31
    v_lshlrev_b32 v30, 4, v31
    v_bfe_u32 v31, v1, 1, 1
    v_lshl_add_u32 v30, v31, 3, v30
    v_and_b32 v31, 1, v1
    v_mul_u32_u24 v31, 1088, v31
    v_add_u32 v30, v30, v31
    v_bfe_u32 v31, v1, 4, 1
    v_mul_u32_u24 v21, 2176, v31
    v_add_u32 v7, v30, v21
    v_lshl_add_u32 v30, v31, 9, v30

    s_add_u32 s60, s14, 1
    s_and_b32 s60, s60, 3
    s_mul_i32 s60, s60, 6528
    s_mov_b32 s43, s60
    v_add_u32 v12, s60, v15
    v_add_u32 v4, s60, v7
    v_add_u32 v8, s60, v30
    s_add_u32 s60, s14, 2
    s_and_b32 s60, s60, 3
    s_mul_i32 s60, s60, 6528
    v_add_u32 v13, s60, v15
    v_add_u32 v5, s60, v7
    v_add_u32 v10, s60, v30
    s_add_u32 s60, s14, 3
    s_and_b32 s60, s60, 3
    s_mul_i32 s60, s60, 6528
    v_add_u32 v14, s60, v15
    v_add_u32 v6, s60, v7
    v_add_u32 v29, s60, v30
    s_add_u32 s60, s14, 4
    s_and_b32 s60, s60, 3
    s_mul_i32 s60, s60, 6528
    v_add_u32 v15, s60, v15
    s_add_u32 s60, s60, 52224
    v_add_u32 v7, s60, v7
    v_add_u32 v30, s60, v30
    v_accvgpr_write_b32 a216, 0
    v_accvgpr_write_b32 a217, 0
    v_accvgpr_write_b32 a218, 0
    v_accvgpr_write_b32 a219, 0
    v_accvgpr_write_b32 a220, 0
    v_accvgpr_write_b32 a221, 0
    v_accvgpr_write_b32 a222, 0
    v_accvgpr_write_b32 a223, 0
    v_accvgpr_write_b32 a224, 0
    v_accvgpr_write_b32 a225, 0
    v_accvgpr_write_b32 a226, 0
    v_accvgpr_write_b32 a227, 0
    v_accvgpr_write_b32 a228, 0
    v_accvgpr_write_b32 a229, 0
    v_accvgpr_write_b32 a230, 0
    v_accvgpr_write_b32 a231, 0
    v_accvgpr_write_b32 a232, 0
    v_accvgpr_write_b32 a233, 0
    v_accvgpr_write_b32 a234, 0
    v_accvgpr_write_b32 a235, 0
    v_accvgpr_write_b32 a236, 0
    v_accvgpr_write_b32 a237, 0
    v_accvgpr_write_b32 a238, 0
    v_accvgpr_write_b32 a239, 0
    v_max3_f32 v9, v80, v81, v82
    v_max_f32 v9, v9, v83
    v_sub_f32 v112, 0, v9
    v_sub_f32 v113, 0, v9
    v_sub_f32 v114, 0, v9
    v_sub_f32 v115, 0, v9
    v_sub_f32 v116, 0, v9
    v_sub_f32 v117, 0, v9
    v_sub_f32 v118, 0, v9
    v_sub_f32 v119, 0, v9
    v_sub_f32 v120, 0, v9
    v_sub_f32 v121, 0, v9
    v_sub_f32 v122, 0, v9
    v_sub_f32 v123, 0, v9
    v_sub_f32 v124, 0, v9
    v_sub_f32 v125, 0, v9
    v_sub_f32 v126, 0, v9
    v_sub_f32 v127, 0, v9
    ds_write_b128 v3, v[112:115]
    v_mov_b32 v80, 0
    v_mov_b32 v88, 0
    v_mov_b32 v81, 0
    v_mov_b32 v89, 0
    v_mov_b32 v82, 0
    v_mov_b32 v90, 0
    v_mov_b32 v83, 0
    v_mov_b32 v91, 0
    v_mov_b32 v9, 0x6c800000
    s_add_u32 s41, s41, 1024
    s_waitcnt lgkmcnt(0)
    s_barrier
    ds_read_b128 a[192:195], v12 offset:0
    ds_read_b128 a[196:199], v12 offset:2176
    ds_read_b128 a[200:203], v12 offset:512
    ds_read_b128 a[204:207], v12 offset:2688
    ds_read_b128 a[208:211], v12 offset:4352
    ds_read_b128 a[212:215], v12 offset:4864
    s_branch L_owner
L_q3:
    v_add_u32 v4, 127488, v16
    ds_read_b128 v[96:99], v4 offset:0
    ds_read_b128 v[100:103], v4 offset:1024
    ds_read_b128 v[104:107], v4 offset:2048
    ds_read_b128 v[108:111], v4 offset:3072
    ds_read_b128 v[112:115], v4 offset:4096
    ds_read_b128 v[116:119], v4 offset:5120
    ds_read_b128 v[120:123], v4 offset:6144
    ds_read_b128 v[124:127], v4 offset:7168
    ds_read_b128 v[128:131], v4 offset:8192
    ds_read_b128 v[132:135], v4 offset:9216
    ds_read_b128 v[136:139], v4 offset:10240
    ds_read_b128 v[140:143], v4 offset:11264
    ds_read_b128 v[144:147], v4 offset:12288
    ds_read_b128 v[148:151], v4 offset:13312
    ds_read_b128 v[152:155], v4 offset:14336
    ds_read_b128 v[156:159], v4 offset:15360
    ds_read_b128 a[244:247], v4 offset:16384
    ds_read_b128 a[248:251], v4 offset:17408
    ds_read_b128 a[216:219], v8 offset:0
    ds_read_b128 a[220:223], v8 offset:128
    ds_read_b128 a[224:227], v8 offset:256
    ds_read_b128 a[228:231], v8 offset:384
    ds_read_b128 a[232:235], v8 offset:512
    ds_read_b128 a[236:239], v8 offset:640
    buffer_load_dwordx2 v[22:23], v0, s[24:27], s57 offen sc1
    s_waitcnt lgkmcnt(15)
    v_mfma_f32_32x32x16_bf16 v[32:47], v[96:99], a[144:147], 0
    v_mfma_f32_32x32x16_bf16 v[32:47], v[100:103], a[148:151], v[32:47]
    v_mfma_f32_32x32x16_bf16 v[32:47], v[104:107], a[152:155], v[32:47]
    v_mfma_f32_32x32x16_bf16 v[32:47], v[108:111], a[156:159], v[32:47]
    v_mfma_f32_32x32x16_bf16 v[32:47], v[112:115], a[160:163], v[32:47]
    v_mfma_f32_32x32x16_bf16 v[32:47], v[116:119], a[164:167], v[32:47]
    s_waitcnt lgkmcnt(12)
    v_mfma_f32_32x32x16_bf16 v[48:63], v[120:123], a[144:147], 0
    v_mfma_f32_32x32x16_bf16 v[48:63], v[124:127], a[148:151], v[48:63]
    v_mfma_f32_32x32x16_bf16 v[48:63], v[128:131], a[152:155], v[48:63]
    v_cvt_pk_bf16_f32 v32, v32, v33
    v_cvt_pk_bf16_f32 v33, v34, v35
    v_cvt_pk_bf16_f32 v34, v36, v37
    v_cvt_pk_bf16_f32 v35, v38, v39
    v_cvt_pk_bf16_f32 v36, v40, v41
    v_cvt_pk_bf16_f32 v37, v42, v43
    v_mfma_f32_32x32x16_bf16 v[48:63], v[132:135], a[156:159], v[48:63]
    v_cvt_pk_bf16_f32 v38, v44, v45
    v_cvt_pk_bf16_f32 v39, v46, v47
    v_accvgpr_write_b32 a96, v32
    v_accvgpr_write_b32 a97, v33
    v_accvgpr_write_b32 a98, v34
    v_accvgpr_write_b32 a99, v35
    v_mfma_f32_32x32x16_bf16 v[48:63], v[136:139], a[160:163], v[48:63]
    v_accvgpr_write_b32 a100, v36
    v_accvgpr_write_b32 a101, v37
    v_accvgpr_write_b32 a102, v38
    v_accvgpr_write_b32 a103, v39
    v_mfma_f32_32x32x16_bf16 v[48:63], v[140:143], a[164:167], v[48:63]
    s_waitcnt lgkmcnt(6)
    v_mfma_f32_32x32x16_bf16 v[64:79], v[144:147], a[144:147], 0
    v_mfma_f32_32x32x16_bf16 v[64:79], v[148:151], a[148:151], v[64:79]
    v_mfma_f32_32x32x16_bf16 v[64:79], v[152:155], a[152:155], v[64:79]
    v_cvt_pk_bf16_f32 v48, v48, v49
    v_cvt_pk_bf16_f32 v49, v50, v51
    v_cvt_pk_bf16_f32 v50, v52, v53
    v_cvt_pk_bf16_f32 v51, v54, v55
    v_cvt_pk_bf16_f32 v52, v56, v57
    v_cvt_pk_bf16_f32 v53, v58, v59
    v_mfma_f32_32x32x16_bf16 v[64:79], v[156:159], a[156:159], v[64:79]
    v_cvt_pk_bf16_f32 v54, v60, v61
    v_cvt_pk_bf16_f32 v55, v62, v63
    v_accvgpr_write_b32 a104, v48
    v_accvgpr_write_b32 a105, v49
    v_accvgpr_write_b32 a106, v50
    v_accvgpr_write_b32 a107, v51
    v_mfma_f32_32x32x16_bf16 v[64:79], a[244:247], a[160:163], v[64:79]
    v_accvgpr_write_b32 a108, v52
    v_accvgpr_write_b32 a109, v53
    v_accvgpr_write_b32 a110, v54
    v_accvgpr_write_b32 a111, v55
    v_mfma_f32_32x32x16_bf16 v[64:79], a[248:251], a[164:167], v[64:79]
    s_nop 11
    v_cvt_pk_bf16_f32 v64, v64, v65
    v_cvt_pk_bf16_f32 v65, v66, v67
    v_cvt_pk_bf16_f32 v66, v68, v69
    v_cvt_pk_bf16_f32 v67, v70, v71
    v_cvt_pk_bf16_f32 v68, v72, v73
    v_cvt_pk_bf16_f32 v69, v74, v75
    v_cvt_pk_bf16_f32 v70, v76, v77
    v_cvt_pk_bf16_f32 v71, v78, v79
    v_accvgpr_write_b32 a112, v64
    v_accvgpr_write_b32 a113, v65
    v_accvgpr_write_b32 a114, v66
    v_accvgpr_write_b32 a115, v67
    v_accvgpr_write_b32 a116, v68
    v_accvgpr_write_b32 a117, v69
    v_accvgpr_write_b32 a118, v70
    v_accvgpr_write_b32 a119, v71
    s_waitcnt lgkmcnt(0)
    s_nop 1
    v_mfma_f32_32x32x16_bf16 v[80:95], a[216:219], a[96:99], 0
    v_mfma_f32_32x32x16_bf16 v[80:95], a[220:223], a[100:103], v[80:95]
    v_mfma_f32_32x32x16_bf16 v[80:95], a[224:227], a[104:107], v[80:95]
    v_mfma_f32_32x32x16_bf16 v[80:95], a[228:231], a[108:111], v[80:95]
    v_mfma_f32_32x32x16_bf16 v[80:95], a[232:235], a[112:115], v[80:95]
    v_mfma_f32_32x32x16_bf16 v[80:95], a[236:239], a[116:119], v[80:95]
    s_mov_b32 s55, 0
L_gw:
    s_waitcnt vmcnt(0)
    v_cmp_ne_u64 vcc, s[4:5], v[22:23]
    s_cmp_eq_u32 s55, 1
    s_mov_b64 s[58:59], vcc
    s_cbranch_scc1 L_gw1
    s_cmp_lg_u32 s58, 0
    s_cbranch_scc1 L_gwn
L_gw0:
    s_mov_b32 s60, 0
    s_mov_b32 m0, s60
    s_nop 0
    buffer_load_dwordx4 v16, s[24:27], s60 offen offset:0 sc1 lds
    buffer_load_dwordx4 v16, s[24:27], s60 offen offset:1088 sc1 lds
    buffer_load_dwordx4 v16, s[24:27], s60 offen offset:2176 sc1 lds
    buffer_load_dwordx4 v16, s[24:27], s60 offen offset:3264 sc1 lds
    s_mov_b32 s60, 4352
    s_mov_b32 m0, s60
    s_nop 0
    buffer_load_dwordx4 v16, s[24:27], s60 offen offset:0 sc1 lds
    buffer_load_dwordx4 v16, s[24:27], s60 offen offset:1088 sc1 lds
    buffer_load_dwordx4 v16, s[24:27], s60 offen offset:2176 sc1 lds
    buffer_load_dwordx4 v16, s[24:27], s60 offen offset:3264 sc1 lds
    s_mov_b32 s60, 8704
    s_mov_b32 m0, s60
    s_nop 0
    buffer_load_dwordx4 v16, s[24:27], s60 offen offset:0 sc1 lds
    buffer_load_dwordx4 v16, s[24:27], s60 offen offset:1088 sc1 lds
    buffer_load_dwordx4 v16, s[24:27], s60 offen offset:2176 sc1 lds
    buffer_load_dwordx4 v16, s[24:27], s60 offen offset:3264 sc1 lds
    s_mov_b32 s60, 13056
    s_mov_b32 m0, s60
    s_nop 0
    buffer_load_dwordx4 v16, s[24:27], s60 offen offset:0 sc1 lds
    buffer_load_dwordx4 v16, s[24:27], s60 offen offset:1088 sc1 lds
    buffer_load_dwordx4 v16, s[24:27], s60 offen offset:2176 sc1 lds
    buffer_load_dwordx4 v16, s[24:27], s60 offen offset:3264 sc1 lds
    s_mov_b32 s60, 17408
    s_mov_b32 m0, s60
    s_nop 0
    buffer_load_dwordx4 v16, s[24:27], s60 offen offset:0 sc1 lds
    buffer_load_dwordx4 v16, s[24:27], s60 offen offset:1088 sc1 lds
    buffer_load_dwordx4 v16, s[24:27], s60 offen offset:2176 sc1 lds
    buffer_load_dwordx4 v16, s[24:27], s60 offen offset:3264 sc1 lds
    s_mov_b32 s60, 21760
    s_mov_b32 m0, s60
    s_nop 0
    buffer_load_dwordx4 v16, s[24:27], s60 offen offset:0 sc1 lds
    buffer_load_dwordx4 v16, s[24:27], s60 offen offset:1088 sc1 lds
    buffer_load_dwordx4 v16, s[24:27], s60 offen offset:2176 sc1 lds
    buffer_load_dwordx4 v16, s[24:27], s60 offen offset:3264 sc1 lds
    s_mov_b32 s55, 1
L_gw1:
    s_cmp_eq_u32 s59, 0
    s_cbranch_scc1 L_gw2
L_gwn:
    buffer_load_dwordx2 v[22:23], v0, s[24:27], s57 offen sc1
    s_add_u32 s15, s15, 1
    s_cmp_lt_u32 s15, 0x8000
    s_cbranch_scc1 L_gw
    s_mov_b32 s59, 0
    s_cmp_eq_u32 s55, 0
    s_cbranch_scc1 L_gw0
L_gw2:
    s_mov_b32 s60, 26112
    s_mov_b32 m0, s60
    s_nop 0
    buffer_load_dwordx4 v16, s[24:27], s60 offen offset:0 sc1 lds
    buffer_load_dwordx4 v16, s[24:27], s60 offen offset:1088 sc1 lds
    buffer_load_dwordx4 v16, s[24:27], s60 offen offset:2176 sc1 lds
    buffer_load_dwordx4 v16, s[24:27], s60 offen offset:3264 sc1 lds
    s_mov_b32 s60, 30464
    s_mov_b32 m0, s60
    s_nop 0
    buffer_load_dwordx4 v16, s[24:27], s60 offen offset:0 sc1 lds
    buffer_load_dwordx4 v16, s[24:27], s60 offen offset:1088 sc1 lds
    buffer_load_dwordx4 v16, s[24:27], s60 offen offset:2176 sc1 lds
    buffer_load_dwordx4 v16, s[24:27], s60 offen offset:3264 sc1 lds
    s_mov_b32 s60, 34816
    s_mov_b32 m0, s60
    s_nop 0
    buffer_load_dwordx4 v16, s[24:27], s60 offen offset:0 sc1 lds
    buffer_load_dwordx4 v16, s[24:27], s60 offen offset:1088 sc1 lds
    buffer_load_dwordx4 v16, s[24:27], s60 offen offset:2176 sc1 lds
    buffer_load_dwordx4 v16, s[24:27], s60 offen offset:3264 sc1 lds
    s_mov_b32 s60, 39168
    s_mov_b32 m0, s60
    s_nop 0
    buffer_load_dwordx4 v16, s[24:27], s60 offen offset:0 sc1 lds
    buffer_load_dwordx4 v16, s[24:27], s60 offen offset:1088 sc1 lds
    buffer_load_dwordx4 v16, s[24:27], s60 offen offset:2176 sc1 lds
    buffer_load_dwordx4 v16, s[24:27], s60 offen offset:3264 sc1 lds
    s_mov_b32 s60, 43520
    s_mov_b32 m0, s60
    s_nop 0
    buffer_load_dwordx4 v16, s[24:27], s60 offen offset:0 sc1 lds
    buffer_load_dwordx4 v16, s[24:27], s60 offen offset:1088 sc1 lds
    buffer_load_dwordx4 v16, s[24:27], s60 offen offset:2176 sc1 lds
    buffer_load_dwordx4 v16, s[24:27], s60 offen offset:3264 sc1 lds
    s_mov_b32 s60, 47872
    s_mov_b32 m0, s60
    s_nop 0
    buffer_load_dwordx4 v16, s[24:27], s60 offen offset:0 sc1 lds
    buffer_load_dwordx4 v16, s[24:27], s60 offen offset:1088 sc1 lds
    buffer_load_dwordx4 v16, s[24:27], s60 offen offset:2176 sc1 lds
    buffer_load_dwordx4 v16, s[24:27], s60 offen offset:3264 sc1 lds
    v_lshrrev_b32 v21, 5, v1
    v_mul_u32_u24 v15, 1088, v21
    v_and_b32 v31, 31, v1
    v_lshl_add_u32 v15, v31, 4, v15
    v_bfe_u32 v31, v1, 2, 2
    v_lshl_add_u32 v31, v21, 2, v31
    v_lshlrev_b32 v30, 4, v31
    v_bfe_u32 v31, v1, 1, 1
    v_lshl_add_u32 v30, v31, 3, v30
    v_and_b32 v31, 1, v1
    v_mul_u32_u24 v31, 1088, v31
    v_add_u32 v30, v30, v31
    v_bfe_u32 v31, v1, 4, 1
    v_mul_u32_u24 v21, 2176, v31
    v_add_u32 v7, v30, v21
    v_lshl_add_u32 v30, v31, 9, v30

    s_add_u32 s60, s14, 1
    s_and_b32 s60, s60, 3
    s_mul_i32 s60, s60, 6528
    s_mov_b32 s43, s60
    v_add_u32 v12, s60, v15
    v_add_u32 v4, s60, v7
    v_add_u32 v8, s60, v30
    s_add_u32 s60, s14, 2
    s_and_b32 s60, s60, 3
    s_mul_i32 s60, s60, 6528
    v_add_u32 v13, s60, v15
    v_add_u32 v5, s60, v7
    v_add_u32 v10, s60, v30
    s_add_u32 s60, s14, 3
    s_and_b32 s60, s60, 3
    s_mul_i32 s60, s60, 6528
    v_add_u32 v14, s60, v15
    v_add_u32 v6, s60, v7
    v_add_u32 v29, s60, v30
    s_add_u32 s60, s14, 4
    s_and_b32 s60, s60, 3
    s_mul_i32 s60, s60, 6528
    v_add_u32 v15, s60, v15
    s_add_u32 s60, s60, 52224
    v_add_u32 v7, s60, v7
    v_add_u32 v30, s60, v30
    v_accvgpr_write_b32 a216, 0
    v_accvgpr_write_b32 a217, 0
    v_accvgpr_write_b32 a218, 0
    v_accvgpr_write_b32 a219, 0
    v_accvgpr_write_b32 a220, 0
    v_accvgpr_write_b32 a221, 0
    v_accvgpr_write_b32 a222, 0
    v_accvgpr_write_b32 a223, 0
    v_accvgpr_write_b32 a224, 0
    v_accvgpr_write_b32 a225, 0
    v_accvgpr_write_b32 a226, 0
    v_accvgpr_write_b32 a227, 0
    v_accvgpr_write_b32 a228, 0
    v_accvgpr_write_b32 a229, 0
    v_accvgpr_write_b32 a230, 0
    v_accvgpr_write_b32 a231, 0
    v_accvgpr_write_b32 a232, 0
    v_accvgpr_write_b32 a233, 0
    v_accvgpr_write_b32 a234, 0
    v_accvgpr_write_b32 a235, 0
    v_accvgpr_write_b32 a236, 0
    v_accvgpr_write_b32 a237, 0
    v_accvgpr_write_b32 a238, 0
    v_accvgpr_write_b32 a239, 0
    v_max3_f32 v9, v80, v81, v82
    v_max_f32 v9, v9, v83
    v_sub_f32 v96, 0, v9
    v_sub_f32 v97, 0, v9
    v_sub_f32 v98, 0, v9
    v_sub_f32 v99, 0, v9
    v_sub_f32 v100, 0, v9
    v_sub_f32 v101, 0, v9
    v_sub_f32 v102, 0, v9
    v_sub_f32 v103, 0, v9
    v_sub_f32 v104, 0, v9
    v_sub_f32 v105, 0, v9
    v_sub_f32 v106, 0, v9
    v_sub_f32 v107, 0, v9
    v_sub_f32 v108, 0, v9
    v_sub_f32 v109, 0, v9
    v_sub_f32 v110, 0, v9
    v_sub_f32 v111, 0, v9
    v_mov_b32 v80, 0
    v_mov_b32 v88, 0
    v_mov_b32 v81, 0
    v_mov_b32 v89, 0
    v_mov_b32 v82, 0
    v_mov_b32 v90, 0
    v_mov_b32 v83, 0
    v_mov_b32 v91, 0
    v_mov_b32 v9, 0x6c800000
    s_add_u32 s41, s41, 1024
    v_add_u32 v2, 78336, v16
    s_waitcnt vmcnt(24)
    s_barrier
    ds_read_b128 a[192:195], v12 offset:0
    ds_read_b128 a[196:199], v12 offset:2176
    ds_read_b128 a[200:203], v12 offset:512
    ds_read_b128 a[204:207], v12 offset:2688
    ds_read_b128 a[208:211], v12 offset:4352
    ds_read_b128 a[212:215], v12 offset:4864
    ds_read_b128 a[120:123], v2 offset:0
    ds_read_b128 a[124:127], v2 offset:1024
    ds_read_b128 a[128:131], v2 offset:2048
    ds_read_b128 a[132:135], v2 offset:3072
    ds_read_b128 a[136:139], v2 offset:4096
    ds_read_b128 a[140:143], v2 offset:5120
    s_waitcnt lgkmcnt(6)
    v_mfma_f32_32x32x16_bf16 v[32:47], a[192:195], a[96:99], v[96:111]
    ds_read_b128 v[112:115], v2 offset:24576
    ds_read_b128 v[116:119], v2 offset:24576
    ds_read_b128 v[120:123], v2 offset:24576
    ds_read_b128 v[124:127], v2 offset:24576
    ds_read_b128 a[144:147], v2 offset:6144
    ds_read_b128 a[148:151], v2 offset:7168
    v_mfma_f32_32x32x16_bf16 v[32:47], a[196:199], a[100:103], v[32:47]
    ds_read_b128 a[152:155], v2 offset:8192
    ds_read_b128 a[156:159], v2 offset:9216
    ds_read_b128 a[160:163], v2 offset:10240
    ds_read_b128 a[164:167], v2 offset:11264
    ds_read_b128 v[128:131], v2 offset:25600
    ds_read_b128 v[132:135], v2 offset:25600
    v_mfma_f32_32x32x16_bf16 v[32:47], a[200:203], a[104:107], v[32:47]
    ds_read_b128 v[136:139], v2 offset:25600
    ds_read_b128 v[140:143], v2 offset:25600
    ds_read_b128 a[168:171], v2 offset:12288
    ds_read_b128 a[172:175], v2 offset:13312
    ds_read_b128 a[176:179], v2 offset:14336
    ds_read_b128 a[180:183], v2 offset:15360
    v_mfma_f32_32x32x16_bf16 v[32:47], a[204:207], a[108:111], v[32:47]
    ds_read_b128 a[184:187], v2 offset:16384
    ds_read_b128 a[188:191], v2 offset:17408
    ds_read_b128 v[144:147], v2 offset:26624
    ds_read_b128 v[148:151], v2 offset:26624
    ds_read_b128 v[152:155], v2 offset:26624
    ds_read_b128 v[156:159], v2 offset:26624
    v_mfma_f32_32x32x16_bf16 v[32:47], a[208:211], a[112:115], v[32:47]
    v_mfma_f32_32x32x16_bf16 v[32:47], a[212:215], a[116:119], v[32:47]
    s_waitcnt lgkmcnt(0)
    s_nop 9
.p2align 6
L_loop_h:
    v_mfma_f32_32x32x16_bf16 v[48:63], a[192:195], a[120:123], v[112:127]
    s_cmp_lt_u32 s28, 5
    ds_read_b128 a[192:195], v13 offset:0
    v_exp_f32 v32, v32
    v_exp_f32 v33, v33
    v_add_f32 v17, v17, v32
    v_mfma_f32_32x32x16_bf16 v[48:63], a[196:199], a[124:127], v[48:63]
    s_cselect_b32 s36, 0, s43
    ds_read_b128 a[196:199], v13 offset:2176
    v_exp_f32 v34, v34
    v_exp_f32 v35, v35
    v_add_f32 v17, v17, v33
    v_mfma_f32_32x32x16_bf16 v[48:63], a[200:203], a[128:131], v[48:63]
    s_cselect_b32 s35, s29, 0x30000
    ds_read_b128 a[200:203], v13 offset:512
    v_cvt_pk_bf16_f32 v32, v32, v33
    v_exp_f32 v36, v36
    v_add_f32 v17, v17, v34
    v_add_f32 v17, v17, v35
    v_mfma_f32_32x32x16_bf16 v[48:63], a[204:207], a[132:135], v[48:63]
    s_sub_u32 s42, s33, s36
    ds_read_b128 a[204:207], v13 offset:2688
    v_exp_f32 v37, v37
    v_cvt_pk_bf16_f32 v33, v34, v35
    v_exp_f32 v38, v38
    v_mfma_f32_32x32x16_bf16 v[48:63], a[208:211], a[136:139], v[48:63]
    s_add_u32 s29, s29, s34
    ds_read_b128 a[208:211], v13 offset:4352
    v_add_f32 v17, v17, v36
    v_exp_f32 v39, v39
    v_add_f32 v17, v17, v37
    v_cvt_pk_bf16_f32 v34, v36, v37
    v_mfma_f32_32x32x16_bf16 v[48:63], a[212:215], a[140:143], v[48:63]
    s_waitcnt lgkmcnt(5)
    ds_read_b128 a[212:215], v13 offset:4864
    v_exp_f32 v40, v40
    v_add_f32 v17, v17, v38
    v_exp_f32 v41, v41
    v_mfma_f32_32x32x16_bf16 v[160:175], a[216:219], v[80:83], v[160:175]
    ds_read_b64_tr_b16 a[216:217], v4 offset:0
    ds_read_b64_tr_b16 a[218:219], v4 offset:128
    v_add_f32 v17, v17, v39
    v_cvt_pk_bf16_f32 v35, v38, v39
    v_exp_f32 v42, v42
    v_mfma_f32_32x32x16_bf16 v[176:191], a[220:223], v[80:83], v[176:191]
    ds_read_b64_tr_b16 a[220:221], v4 offset:512
    ds_read_b64_tr_b16 a[222:223], v4 offset:640
    v_add_f32 v17, v17, v40
    v_exp_f32 v43, v43
    v_add_f32 v17, v17, v41
    v_mfma_f32_32x32x16_bf16 v[192:207], a[224:227], v[80:83], v[192:207]
    ds_read_b64_tr_b16 a[224:225], v8 offset:4352
    ds_read_b64_tr_b16 a[226:227], v8 offset:4480
    v_cvt_pk_bf16_f32 v40, v40, v41
    v_exp_f32 v44, v44
    v_add_f32 v17, v17, v42
    v_mfma_f32_32x32x16_bf16 v[160:175], a[228:231], v[88:91], v[160:175]
    ds_read_b64_tr_b16 a[228:229], v4 offset:256
    ds_read_b64_tr_b16 a[230:231], v4 offset:384
    v_exp_f32 v45, v45
    v_add_f32 v17, v17, v43
    v_cvt_pk_bf16_f32 v41, v42, v43
    v_mfma_f32_32x32x16_bf16 v[176:191], a[232:235], v[88:91], v[176:191]
    ds_read_b64_tr_b16 a[232:233], v4 offset:768
    ds_read_b64_tr_b16 a[234:235], v4 offset:896
    v_exp_f32 v46, v46
    v_add_f32 v17, v17, v44
    v_add_f32 v17, v17, v45
    v_mfma_f32_32x32x16_bf16 v[192:207], a[236:239], v[88:91], v[192:207]
    s_waitcnt lgkmcnt(10)
    ds_read_b64_tr_b16 a[236:237], v8 offset:4608
    ds_read_b64_tr_b16 a[238:239], v8 offset:4736
    v_exp_f32 v47, v47
    v_cvt_pk_bf16_f32 v42, v44, v45
    v_add_f32 v17, v17, v46
    v_mfma_f32_32x32x16_bf16 v[64:79], a[192:195], a[96:99], v[96:111]
    buffer_load_dwordx2 v[22:23], v11, s[24:27], s41 offen sc1
    v_add_f32 v17, v17, v47
    v_cvt_pk_bf16_f32 v43, v46, v47
    v_exp_f32 v48, v48
    v_mfma_f32_32x32x16_bf16 v[64:79], a[196:199], a[100:103], v[64:79]
    v_exp_f32 v49, v49
    v_exp_f32 v50, v50
    v_add_f32 v18, v18, v48
    v_add_f32 v18, v18, v49
    v_mfma_f32_32x32x16_bf16 v[64:79], a[200:203], a[104:107], v[64:79]
    v_exp_f32 v51, v51
    v_cvt_pk_bf16_f32 v48, v48, v49
    v_exp_f32 v52, v52
    v_add_f32 v18, v18, v50
    v_mfma_f32_32x32x16_bf16 v[64:79], a[204:207], a[108:111], v[64:79]
    v_exp_f32 v53, v53
    v_add_f32 v18, v18, v51
    v_cvt_pk_bf16_f32 v49, v50, v51
    v_exp_f32 v54, v54
    v_mfma_f32_32x32x16_bf16 v[64:79], a[208:211], a[112:115], v[64:79]
    v_add_f32 v18, v18, v52
    v_exp_f32 v55, v55
    v_add_f32 v18, v18, v53
    v_cvt_pk_bf16_f32 v50, v52, v53
    v_mfma_f32_32x32x16_bf16 v[64:79], a[212:215], a[116:119], v[64:79]
    s_waitcnt lgkmcnt(0)
    v_exp_f32 v56, v56
    v_add_f32 v18, v18, v54
    v_exp_f32 v57, v57
    v_mfma_f32_32x32x16_bf16 v[160:175], a[216:219], v[32:35], v[160:175]
    v_add_f32 v18, v18, v55
    v_cvt_pk_bf16_f32 v51, v54, v55
    v_exp_f32 v58, v58
    v_add_f32 v18, v18, v56
    v_add_f32 v18, v18, v57
    v_mfma_f32_32x32x16_bf16 v[176:191], a[220:223], v[32:35], v[176:191]
    v_exp_f32 v59, v59
    v_cvt_pk_bf16_f32 v56, v56, v57
    v_exp_f32 v60, v60
    v_mfma_f32_32x32x16_bf16 v[192:207], a[224:227], v[32:35], v[192:207]
    v_add_f32 v18, v18, v58
    v_exp_f32 v61, v61
    v_add_f32 v18, v18, v59
    v_cvt_pk_bf16_f32 v57, v58, v59
    v_mfma_f32_32x32x16_bf16 v[160:175], a[228:231], v[40:43], v[160:175]
    v_exp_f32 v62, v62
    v_add_f32 v18, v18, v60
    v_exp_f32 v63, v63
    v_add_f32 v18, v18, v61
    v_mfma_f32_32x32x16_bf16 v[176:191], a[232:235], v[40:43], v[176:191]
    v_cvt_pk_bf16_f32 v58, v60, v61
    v_add_f32 v18, v18, v62
    v_add_f32 v18, v18, v63
    v_cvt_pk_bf16_f32 v59, v62, v63
    v_add_u32 v13, s33, v13
    v_mfma_f32_32x32x16_bf16 v[192:207], a[236:239], v[40:43], v[192:207]
    v_add_u32 v4, s42, v4
    v_add_u32 v8, s42, v8
    v_add_u32 v7, s34, v7
    v_add_u32 v30, s34, v30
    v_add_u32 v12, s42, v12
    v_mfma_f32_32x32x16_bf16 v[32:47], a[192:195], a[144:147], v[128:143]
    ds_read_b128 a[192:195], v14 offset:0
    v_exp_f32 v64, v64
    v_exp_f32 v65, v65
    v_add_f32 v17, v17, v64
    v_mfma_f32_32x32x16_bf16 v[32:47], a[196:199], a[148:151], v[32:47]
    ds_read_b128 a[196:199], v14 offset:2176
    v_exp_f32 v66, v66
    v_exp_f32 v67, v67
    v_add_f32 v17, v17, v65
    v_mfma_f32_32x32x16_bf16 v[32:47], a[200:203], a[152:155], v[32:47]
    ds_read_b128 a[200:203], v14 offset:512
    v_cvt_pk_bf16_f32 v64, v64, v65
    v_exp_f32 v68, v68
    v_add_f32 v17, v17, v66
    v_add_f32 v17, v17, v67
    v_mfma_f32_32x32x16_bf16 v[32:47], a[204:207], a[156:159], v[32:47]
    ds_read_b128 a[204:207], v14 offset:2688
    v_exp_f32 v69, v69
    v_cvt_pk_bf16_f32 v65, v66, v67
    v_exp_f32 v70, v70
    v_mfma_f32_32x32x16_bf16 v[32:47], a[208:211], a[160:163], v[32:47]
    ds_read_b128 a[208:211], v14 offset:4352
    v_add_f32 v17, v17, v68
    v_exp_f32 v71, v71
    v_add_f32 v17, v17, v69
    v_cvt_pk_bf16_f32 v66, v68, v69
    v_mfma_f32_32x32x16_bf16 v[32:47], a[212:215], a[164:167], v[32:47]
    ds_read_b128 a[212:215], v14 offset:4864
    v_exp_f32 v72, v72
    v_add_f32 v17, v17, v70
    v_exp_f32 v73, v73
    v_mfma_f32_32x32x16_bf16 v[208:223], a[216:219], v[48:51], v[208:223]
    ds_read_b64_tr_b16 a[216:217], v5 offset:0
    ds_read_b64_tr_b16 a[218:219], v5 offset:128
    v_add_f32 v17, v17, v71
    v_cvt_pk_bf16_f32 v67, v70, v71
    v_exp_f32 v74, v74
    v_mfma_f32_32x32x16_bf16 v[224:239], a[220:223], v[48:51], v[224:239]
    ds_read_b64_tr_b16 a[220:221], v5 offset:512
    ds_read_b64_tr_b16 a[222:223], v5 offset:640
    v_add_f32 v17, v17, v72
    v_exp_f32 v75, v75
    v_add_f32 v17, v17, v73
    v_mfma_f32_32x32x16_bf16 v[240:255], a[224:227], v[48:51], v[240:255]
    ds_read_b64_tr_b16 a[224:225], v10 offset:4352
    ds_read_b64_tr_b16 a[226:227], v10 offset:4480
    v_cvt_pk_bf16_f32 v72, v72, v73
    v_exp_f32 v76, v76
    v_add_f32 v17, v17, v74
    v_mfma_f32_32x32x16_bf16 v[208:223], a[228:231], v[56:59], v[208:223]
    ds_read_b64_tr_b16 a[228:229], v5 offset:256
    ds_read_b64_tr_b16 a[230:231], v5 offset:384
    v_exp_f32 v77, v77
    v_add_f32 v17, v17, v75
    v_cvt_pk_bf16_f32 v73, v74, v75
    v_mfma_f32_32x32x16_bf16 v[224:239], a[232:235], v[56:59], v[224:239]
    ds_read_b64_tr_b16 a[232:233], v5 offset:768
    ds_read_b64_tr_b16 a[234:235], v5 offset:896
    v_exp_f32 v78, v78
    v_add_f32 v17, v17, v76
    v_add_f32 v17, v17, v77
    v_mfma_f32_32x32x16_bf16 v[240:255], a[236:239], v[56:59], v[240:255]
    s_waitcnt lgkmcnt(10)
    ds_read_b64_tr_b16 a[236:237], v10 offset:4608
    ds_read_b64_tr_b16 a[238:239], v10 offset:4736
    v_exp_f32 v79, v79
    v_cvt_pk_bf16_f32 v74, v76, v77
    v_add_f32 v17, v17, v78
    v_mfma_f32_32x32x16_bf16 v[48:63], a[192:195], a[96:99], v[96:111]
    s_waitcnt vmcnt(0)
    s_barrier
    v_add_f32 v17, v17, v79
    v_cvt_pk_bf16_f32 v75, v78, v79
    v_exp_f32 v32, v32
    v_mfma_f32_32x32x16_bf16 v[48:63], a[196:199], a[100:103], v[48:63]
    v_cmp_ne_u64 vcc, s[4:5], v[22:23]
    v_exp_f32 v33, v33
    v_exp_f32 v34, v34
    v_add_f32 v19, v19, v32
    v_mfma_f32_32x32x16_bf16 v[48:63], a[200:203], a[104:107], v[48:63]
    s_mov_b32 m0, s35
    v_exp_f32 v35, v35
    v_add_f32 v19, v19, v33
    v_cvt_pk_bf16_f32 v32, v32, v33
    v_exp_f32 v36, v36
    v_mfma_f32_32x32x16_bf16 v[48:63], a[204:207], a[108:111], v[48:63]
    s_cbranch_vccnz L_slow_h
L_back_h:
    v_add_f32 v19, v19, v34
    v_exp_f32 v37, v37
    v_add_f32 v19, v19, v35
    v_cvt_pk_bf16_f32 v33, v34, v35
    v_add_f32 v19, v19, v36
    v_mfma_f32_32x32x16_bf16 v[48:63], a[208:211], a[112:115], v[48:63]
    buffer_load_dwordx4 v16, s[24:27], s30 offen offset:0 sc1 lds
    v_exp_f32 v38, v38
    v_exp_f32 v39, v39
    v_add_f32 v19, v19, v37
    v_mfma_f32_32x32x16_bf16 v[48:63], a[212:215], a[116:119], v[48:63]
    s_waitcnt lgkmcnt(0)
    v_cvt_pk_bf16_f32 v34, v36, v37
    v_exp_f32 v40, v40
    v_add_f32 v19, v19, v38
    v_exp_f32 v41, v41
    v_mfma_f32_32x32x16_bf16 v[160:175], a[216:219], v[64:67], v[160:175]
    buffer_load_dwordx4 v16, s[24:27], s30 offen offset:1088 sc1 lds
    v_add_f32 v19, v19, v39
    v_cvt_pk_bf16_f32 v35, v38, v39
    v_exp_f32 v42, v42
    v_mfma_f32_32x32x16_bf16 v[176:191], a[220:223], v[64:67], v[176:191]
    buffer_load_dwordx4 v16, s[24:27], s30 offen offset:2176 sc1 lds
    v_add_f32 v19, v19, v40
    v_exp_f32 v43, v43
    v_add_f32 v19, v19, v41
    v_mfma_f32_32x32x16_bf16 v[192:207], a[224:227], v[64:67], v[192:207]
    buffer_load_dwordx4 v16, s[24:27], s30 offen offset:3264 sc1 lds
    v_cvt_pk_bf16_f32 v40, v40, v41
    v_exp_f32 v44, v44
    v_add_f32 v19, v19, v42
    v_add_f32 v19, v19, v43
    v_mfma_f32_32x32x16_bf16 v[160:175], a[228:231], v[72:75], v[160:175]
    s_add_u32 m0, s35, 4352
    v_exp_f32 v45, v45
    v_cvt_pk_bf16_f32 v41, v42, v43
    v_exp_f32 v46, v46
    v_mfma_f32_32x32x16_bf16 v[176:191], a[232:235], v[72:75], v[176:191]
    buffer_load_dwordx4 v16, s[24:27], s31 offen offset:0 sc1 lds
    v_add_f32 v19, v19, v44
    v_exp_f32 v47, v47
    v_add_f32 v19, v19, v45
    v_cvt_pk_bf16_f32 v42, v44, v45
    v_mfma_f32_32x32x16_bf16 v[192:207], a[236:239], v[72:75], v[192:207]
    buffer_load_dwordx4 v16, s[24:27], s31 offen offset:1088 sc1 lds
    v_add_f32 v19, v19, v46
    v_add_f32 v19, v19, v47
    v_cvt_pk_bf16_f32 v43, v46, v47
    v_add_u32 v14, s33, v14
    v_mfma_f32_32x32x16_bf16 v[64:79], a[192:195], a[168:171], v[144:159]
    s_add_u32 s41, s41, 512
    ds_read_b128 a[192:195], v15 offset:0
    v_exp_f32 v48, v48
    v_exp_f32 v49, v49
    v_add_f32 v17, v17, v48
    v_mfma_f32_32x32x16_bf16 v[64:79], a[196:199], a[172:175], v[64:79]
    s_min_u32 s41, s41, s61
    ds_read_b128 a[196:199], v15 offset:2176
    v_exp_f32 v50, v50
    v_exp_f32 v51, v51
    v_add_f32 v17, v17, v49
    v_mfma_f32_32x32x16_bf16 v[64:79], a[200:203], a[176:179], v[64:79]
    s_add_u32 s30, s30, 26112
    ds_read_b128 a[200:203], v15 offset:512
    v_cvt_pk_bf16_f32 v48, v48, v49
    v_exp_f32 v52, v52
    v_add_f32 v17, v17, v50
    v_add_f32 v17, v17, v51
    v_mfma_f32_32x32x16_bf16 v[64:79], a[204:207], a[180:183], v[64:79]
    s_add_u32 s31, s31, 26112
    ds_read_b128 a[204:207], v15 offset:2688
    v_exp_f32 v53, v53
    v_cvt_pk_bf16_f32 v49, v50, v51
    v_exp_f32 v54, v54
    v_mfma_f32_32x32x16_bf16 v[64:79], a[208:211], a[184:187], v[64:79]
    ds_read_b128 a[208:211], v15 offset:4352
    v_add_f32 v17, v17, v52
    v_exp_f32 v55, v55
    v_add_f32 v17, v17, v53
    v_cvt_pk_bf16_f32 v50, v52, v53
    v_mfma_f32_32x32x16_bf16 v[64:79], a[212:215], a[188:191], v[64:79]
    ds_read_b128 a[212:215], v15 offset:4864
    v_exp_f32 v56, v56
    v_add_f32 v17, v17, v54
    v_exp_f32 v57, v57
    v_mfma_f32_32x32x16_bf16 a[0:15], a[216:219], v[32:35], a[0:15]
    ds_read_b64_tr_b16 a[216:217], v6 offset:0
    ds_read_b64_tr_b16 a[218:219], v6 offset:128
    v_add_f32 v17, v17, v55
    v_cvt_pk_bf16_f32 v51, v54, v55
    v_exp_f32 v58, v58
    v_mfma_f32_32x32x16_bf16 a[16:31], a[220:223], v[32:35], a[16:31]
    ds_read_b64_tr_b16 a[220:221], v6 offset:512
    ds_read_b64_tr_b16 a[222:223], v6 offset:640
    v_add_f32 v17, v17, v56
    v_exp_f32 v59, v59
    v_add_f32 v17, v17, v57
    v_mfma_f32_32x32x16_bf16 a[32:47], a[224:227], v[32:35], a[32:47]
    ds_read_b64_tr_b16 a[224:225], v29 offset:4352
    ds_read_b64_tr_b16 a[226:227], v29 offset:4480
    v_cvt_pk_bf16_f32 v56, v56, v57
    v_exp_f32 v60, v60
    v_add_f32 v17, v17, v58
    v_mfma_f32_32x32x16_bf16 a[0:15], a[228:231], v[40:43], a[0:15]
    ds_read_b64_tr_b16 a[228:229], v6 offset:256
    ds_read_b64_tr_b16 a[230:231], v6 offset:384
    v_exp_f32 v61, v61
    v_add_f32 v17, v17, v59
    v_cvt_pk_bf16_f32 v57, v58, v59
    v_mfma_f32_32x32x16_bf16 a[16:31], a[232:235], v[40:43], a[16:31]
    ds_read_b64_tr_b16 a[232:233], v6 offset:768
    ds_read_b64_tr_b16 a[234:235], v6 offset:896
    v_exp_f32 v62, v62
    v_add_f32 v17, v17, v60
    v_add_f32 v17, v17, v61
    v_mfma_f32_32x32x16_bf16 a[32:47], a[236:239], v[40:43], a[32:47]
    s_waitcnt lgkmcnt(10)
    ds_read_b64_tr_b16 a[236:237], v29 offset:4608
    ds_read_b64_tr_b16 a[238:239], v29 offset:4736
    v_exp_f32 v63, v63
    v_cvt_pk_bf16_f32 v58, v60, v61
    v_add_f32 v17, v17, v62
    v_mfma_f32_32x32x16_bf16 v[80:95], a[192:195], a[96:99], v[96:111]
    ds_read_b128 a[192:195], v12 offset:0
    v_add_f32 v17, v17, v63
    v_cvt_pk_bf16_f32 v59, v62, v63
    v_exp_f32 v64, v64
    v_mfma_f32_32x32x16_bf16 v[80:95], a[196:199], a[100:103], v[80:95]
    ds_read_b128 a[196:199], v12 offset:2176
    v_exp_f32 v65, v65
    v_exp_f32 v66, v66
    v_add_f32 v20, v20, v64
    v_mfma_f32_32x32x16_bf16 v[80:95], a[200:203], a[104:107], v[80:95]
    ds_read_b128 a[200:203], v12 offset:512
    v_exp_f32 v67, v67
    v_add_f32 v20, v20, v65
    v_cvt_pk_bf16_f32 v64, v64, v65
    v_add_f32 v20, v20, v66
    v_mfma_f32_32x32x16_bf16 v[80:95], a[204:207], a[108:111], v[80:95]
    ds_read_b128 a[204:207], v12 offset:2688
    v_exp_f32 v68, v68
    v_exp_f32 v69, v69
    v_add_f32 v20, v20, v67
    v_mfma_f32_32x32x16_bf16 v[80:95], a[208:211], a[112:115], v[80:95]
    ds_read_b128 a[208:211], v12 offset:4352
    v_cvt_pk_bf16_f32 v65, v66, v67
    v_exp_f32 v70, v70
    v_add_f32 v20, v20, v68
    v_add_f32 v20, v20, v69
    v_mfma_f32_32x32x16_bf16 v[80:95], a[212:215], a[116:119], v[80:95]
    s_waitcnt lgkmcnt(5)
    ds_read_b128 a[212:215], v12 offset:4864
    v_exp_f32 v71, v71
    v_cvt_pk_bf16_f32 v66, v68, v69
    v_exp_f32 v72, v72
    v_mfma_f32_32x32x16_bf16 v[160:175], a[216:219], v[48:51], v[160:175]
    v_add_f32 v20, v20, v70
    v_exp_f32 v73, v73
    v_add_f32 v20, v20, v71
    v_cvt_pk_bf16_f32 v67, v70, v71
    v_add_f32 v20, v20, v72
    v_mfma_f32_32x32x16_bf16 v[176:191], a[220:223], v[48:51], v[176:191]
    v_exp_f32 v74, v74
    v_exp_f32 v75, v75
    v_add_f32 v20, v20, v73
    v_cvt_pk_bf16_f32 v72, v72, v73
    v_mfma_f32_32x32x16_bf16 v[192:207], a[224:227], v[48:51], v[192:207]
    v_exp_f32 v76, v76
    v_add_f32 v20, v20, v74
    v_exp_f32 v77, v77
    v_add_f32 v20, v20, v75
    v_mfma_f32_32x32x16_bf16 v[160:175], a[228:231], v[56:59], v[160:175]
    v_cvt_pk_bf16_f32 v73, v74, v75
    v_exp_f32 v78, v78
    v_add_f32 v20, v20, v76
    v_exp_f32 v79, v79
    v_mfma_f32_32x32x16_bf16 v[176:191], a[232:235], v[56:59], v[176:191]
    v_add_f32 v20, v20, v77
    v_cvt_pk_bf16_f32 v74, v76, v77
    v_add_f32 v20, v20, v78
    v_add_f32 v20, v20, v79
    v_cvt_pk_bf16_f32 v75, v78, v79
    v_mfma_f32_32x32x16_bf16 v[192:207], a[236:239], v[56:59], v[192:207]
    s_waitcnt lgkmcnt(0)
    v_add_u32 v5, s33, v5
    v_add_u32 v10, s33, v10
    v_add_u32 v15, s33, v15
    v_add_u32 v6, s33, v6
    v_add_u32 v29, s33, v29
    v_mfma_f32_32x32x16_bf16 v[32:47], a[192:195], a[96:99], v[96:111]
    v_exp_f32 v80, v80
    v_exp_f32 v81, v81
    v_exp_f32 v82, v82
    v_mfma_f32_32x32x16_bf16 v[32:47], a[196:199], a[100:103], v[32:47]
    s_add_u32 s36, s33, s34
    v_add_f32 v17, v17, v80
    v_exp_f32 v83, v83
    v_add_f32 v17, v17, v81
    v_cvt_pk_bf16_f32 v80, v80, v81
    v_add_f32 v17, v17, v82
    v_mfma_f32_32x32x16_bf16 v[32:47], a[200:203], a[104:107], v[32:47]
    s_mov_b32 s34, s33
    v_exp_f32 v84, v84
    v_exp_f32 v85, v85
    v_add_f32 v17, v17, v83
    v_cvt_pk_bf16_f32 v81, v82, v83
    v_mfma_f32_32x32x16_bf16 v[32:47], a[204:207], a[108:111], v[32:47]
    s_sub_u32 s33, 0, s36
    v_exp_f32 v86, v86
    v_add_f32 v17, v17, v84
    v_exp_f32 v87, v87
    v_add_f32 v17, v17, v85
    v_mfma_f32_32x32x16_bf16 v[32:47], a[208:211], a[112:115], v[32:47]
    s_add_u32 s28, s28, 1
    v_cvt_pk_bf16_f32 v82, v84, v85
    v_exp_f32 v88, v88
    v_add_f32 v17, v17, v86
    v_exp_f32 v89, v89
    v_mfma_f32_32x32x16_bf16 v[32:47], a[212:215], a[116:119], v[32:47]
    s_cmp_lt_u32 s28, 6
    v_add_f32 v17, v17, v87
    v_cvt_pk_bf16_f32 v83, v86, v87
    v_exp_f32 v90, v90
    v_add_f32 v17, v17, v88
    v_add_f32 v17, v17, v89
    v_mfma_f32_32x32x16_bf16 a[48:63], a[216:219], v[64:67], a[48:63]
    ds_read_b64_tr_b16 a[216:217], v7 offset:0
    ds_read_b64_tr_b16 a[218:219], v7 offset:128
    v_exp_f32 v91, v91
    v_cvt_pk_bf16_f32 v88, v88, v89
    v_mfma_f32_32x32x16_bf16 a[64:79], a[220:223], v[64:67], a[64:79]
    ds_read_b64_tr_b16 a[220:221], v7 offset:512
    ds_read_b64_tr_b16 a[222:223], v7 offset:640
    v_exp_f32 v92, v92
    v_add_f32 v17, v17, v90
    v_mfma_f32_32x32x16_bf16 a[80:95], a[224:227], v[64:67], a[80:95]
    ds_read_b64_tr_b16 a[224:225], v30 offset:4352
    ds_read_b64_tr_b16 a[226:227], v30 offset:4480
    v_exp_f32 v93, v93
    v_add_f32 v17, v17, v91
    v_cvt_pk_bf16_f32 v89, v90, v91
    v_mfma_f32_32x32x16_bf16 a[48:63], a[228:231], v[72:75], a[48:63]
    ds_read_b64_tr_b16 a[228:229], v7 offset:256
    ds_read_b64_tr_b16 a[230:231], v7 offset:384
    v_exp_f32 v94, v94
    v_add_f32 v17, v17, v92
    v_mfma_f32_32x32x16_bf16 a[64:79], a[232:235], v[72:75], a[64:79]
    ds_read_b64_tr_b16 a[232:233], v7 offset:768
    ds_read_b64_tr_b16 a[234:235], v7 offset:896
    v_exp_f32 v95, v95
    v_add_f32 v17, v17, v93
    v_mfma_f32_32x32x16_bf16 a[80:95], a[236:239], v[72:75], a[80:95]
    ds_read_b64_tr_b16 a[236:237], v30 offset:4608
    ds_read_b64_tr_b16 a[238:239], v30 offset:4736
    v_cvt_pk_bf16_f32 v90, v92, v93
    v_add_f32 v17, v17, v94
    v_add_f32 v17, v17, v95
    v_cvt_pk_bf16_f32 v91, v94, v95
    s_cbranch_scc1 L_loop_h
    v_add_u32 v5, 78336, v16
    v_lshlrev_b32 v2, 2, v1
    v_add_u32 v2, 78336, v2
    s_mov_b32 s58, 0x12800000
    s_waitcnt lgkmcnt(0)
    ds_write_b128 v5, v[208:211] offset:0
    ds_write_b128 v5, v[212:215] offset:1024
    v_mfma_f32_32x32x16_bf16 v[160:175], a[216:219], v[80:83], v[160:175]
    ds_read_b64_tr_b16 a[216:217], v4 offset:0
    ds_read_b64_tr_b16 a[218:219], v4 offset:128
    ds_write_b128 v5, v[216:219] offset:2048
    ds_write_b128 v5, v[220:223] offset:3072
    v_exp_f32 v32, v32
    ds_write_b128 v5, v[224:227] offset:4096
    v_exp_f32 v33, v33
    ds_write_b128 v5, v[228:231] offset:5120
    v_exp_f32 v34, v34
    ds_write_b128 v5, v[232:235] offset:6144
    v_exp_f32 v35, v35
    ds_write_b128 v5, v[236:239] offset:7168
    v_mfma_f32_32x32x16_bf16 v[176:191], a[220:223], v[80:83], v[176:191]
    ds_read_b64_tr_b16 a[220:221], v4 offset:512
    ds_read_b64_tr_b16 a[222:223], v4 offset:640
    ds_write_b128 v5, v[240:243] offset:8192
    v_exp_f32 v36, v36
    ds_write_b128 v5, v[244:247] offset:9216
    v_exp_f32 v37, v37
    ds_write_b128 v5, v[248:251] offset:10240
    v_exp_f32 v38, v38
    ds_write_b128 v5, v[252:255] offset:11264
    v_exp_f32 v39, v39
    ds_write_b32 v2, v18 offset:12288
    v_add_f32 v17, v17, v32
    ds_write_b128 v5, a[0:3] offset:12544
    v_mfma_f32_32x32x16_bf16 v[192:207], a[224:227], v[80:83], v[192:207]
    ds_read_b64_tr_b16 a[224:225], v8 offset:4352
    ds_read_b64_tr_b16 a[226:227], v8 offset:4480
    ds_write_b128 v5, a[4:7] offset:13568
    v_add_f32 v17, v17, v33
    ds_write_b128 v5, a[8:11] offset:14592
    v_add_f32 v17, v17, v34
    ds_write_b128 v5, a[12:15] offset:15616
    v_add_f32 v17, v17, v35
    ds_write_b128 v5, a[16:19] offset:16640
    v_add_f32 v17, v17, v36
    ds_write_b128 v5, a[20:23] offset:17664
    v_add_f32 v17, v17, v37
    ds_write_b128 v5, a[24:27] offset:18688
    v_mfma_f32_32x32x16_bf16 v[160:175], a[228:231], v[88:91], v[160:175]
    ds_write_b128 v5, a[28:31] offset:19712
    v_add_f32 v17, v17, v38
    ds_write_b128 v5, a[32:35] offset:20736
    v_add_f32 v17, v17, v39
    ds_write_b128 v5, a[36:39] offset:21760
    v_cvt_pk_bf16_f32 v32, v32, v33
    ds_write_b128 v5, a[40:43] offset:22784
    v_cvt_pk_bf16_f32 v33, v34, v35
    ds_write_b128 v5, a[44:47] offset:23808
    v_cvt_pk_bf16_f32 v34, v36, v37
    ds_write_b32 v2, v19 offset:24832
    v_mfma_f32_32x32x16_bf16 v[176:191], a[232:235], v[88:91], v[176:191]
    ds_write_b128 v5, a[48:51] offset:25088
    v_cvt_pk_bf16_f32 v35, v38, v39
    ds_write_b128 v5, a[52:55] offset:26112
    ds_write_b128 v5, a[56:59] offset:27136
    ds_write_b128 v5, a[60:63] offset:28160
    ds_write_b128 v5, a[64:67] offset:29184
    ds_write_b128 v5, a[68:71] offset:30208
    v_mfma_f32_32x32x16_bf16 v[192:207], a[236:239], v[88:91], v[192:207]
    ds_write_b128 v5, a[72:75] offset:31232
    ds_write_b128 v5, a[76:79] offset:32256
    ds_write_b128 v5, a[80:83] offset:33280
    ds_write_b128 v5, a[84:87] offset:34304
    ds_write_b128 v5, a[88:91] offset:35328
    ds_write_b128 v5, a[92:95] offset:36352
    ds_write_b32 v2, v20 offset:37376
    s_waitcnt lgkmcnt(0)
    s_barrier
    v_mfma_f32_32x32x16_bf16 v[160:175], a[216:219], v[32:35], v[160:175]
    ds_read_b128 v[96:99], v16 offset:6528
    ds_read_b128 v[100:103], v16 offset:7616
    ds_read_b128 v[104:107], v16 offset:8704
    ds_read_b128 v[108:111], v16 offset:9792
    ds_read_b128 v[112:115], v16 offset:10880
    ds_read_b128 v[116:119], v16 offset:11968
    v_mfma_f32_32x32x16_bf16 v[176:191], a[220:223], v[32:35], v[176:191]
    ds_read_b128 v[120:123], v16 offset:13056
    ds_read_b128 v[124:127], v16 offset:14144
    ds_read_b128 v[128:131], v16 offset:15232
    ds_read_b128 v[132:135], v16 offset:16320
    ds_read_b128 v[136:139], v16 offset:17408
    ds_read_b128 v[140:143], v16 offset:18496
    v_mfma_f32_32x32x16_bf16 v[192:207], a[224:227], v[32:35], v[192:207]
    ds_read_b128 v[144:147], v16 offset:19584
    ds_read_b128 v[148:151], v16 offset:20672
    ds_read_b128 v[152:155], v16 offset:21760
    ds_read_b128 v[156:159], v16 offset:22848
    ds_read_b128 a[244:247], v16 offset:23936
    ds_read_b128 a[248:251], v16 offset:25024
    v_mov_b32 v2, v17
    s_nop 1
    v_permlane32_swap_b32 v17, v2
    s_nop 0
    v_add_f32 v2, v17, v2
    v_med3_f32 v3, v2, s58, v9
    v_cmp_neq_f32 vcc, v3, v2
    s_cbranch_vccnz L_redo_h
L_redone_h:
    v_rcp_f32 v2, v2
    s_nop 1
    v_mov_b32 v3, v2
    v_cvt_pk_bf16_f32 v32, v160, v161
    v_cvt_pk_bf16_f32 v33, v162, v163
    v_cvt_pk_bf16_f32 v34, v164, v165
    v_cvt_pk_bf16_f32 v35, v166, v167
    v_cvt_pk_bf16_f32 v36, v168, v169
    v_cvt_pk_bf16_f32 v37, v170, v171
    v_cvt_pk_bf16_f32 v38, v172, v173
    v_cvt_pk_bf16_f32 v39, v174, v175
    s_waitcnt lgkmcnt(0)
    v_mfma_f32_32x32x16_bf16 v[160:175], v[96:99], v[32:35], 0
    v_cvt_pk_bf16_f32 v40, v176, v177
    v_cvt_pk_bf16_f32 v41, v178, v179
    v_cvt_pk_bf16_f32 v42, v180, v181
    v_cvt_pk_bf16_f32 v43, v182, v183
    v_cvt_pk_bf16_f32 v44, v184, v185
    v_cvt_pk_bf16_f32 v45, v186, v187
    v_mfma_f32_32x32x16_bf16 v[160:175], v[100:103], v[36:39], v[160:175]
    v_cvt_pk_bf16_f32 v46, v188, v189
    v_cvt_pk_bf16_f32 v47, v190, v191
    v_cvt_pk_bf16_f32 v48, v192, v193
    v_cvt_pk_bf16_f32 v49, v194, v195
    v_cvt_pk_bf16_f32 v50, v196, v197
    v_cvt_pk_bf16_f32 v51, v198, v199
    v_mfma_f32_32x32x16_bf16 v[160:175], v[104:107], v[40:43], v[160:175]
    v_cvt_pk_bf16_f32 v52, v200, v201
    v_cvt_pk_bf16_f32 v53, v202, v203
    v_cvt_pk_bf16_f32 v54, v204, v205
    v_cvt_pk_bf16_f32 v55, v206, v207
    v_mfma_f32_32x32x16_bf16 v[160:175], v[108:111], v[44:47], v[160:175]
    v_mfma_f32_32x32x16_bf16 v[160:175], v[112:115], v[48:51], v[160:175]
    v_mfma_f32_32x32x16_bf16 v[160:175], v[116:119], v[52:55], v[160:175]
    v_mfma_f32_32x32x16_bf16 v[176:191], v[120:123], v[32:35], 0
    v_mfma_f32_32x32x16_bf16 v[176:191], v[124:127], v[36:39], v[176:191]
    v_mfma_f32_32x32x16_bf16 v[176:191], v[128:131], v[40:43], v[176:191]
    v_mul_f32 v160, v2, v160
    v_mul_f32 v161, v2, v161
    v_cvt_pk_bf16_f32 v160, v160, v161
    v_mul_f32 v162, v2, v162
    v_mul_f32 v163, v2, v163
    v_cvt_pk_bf16_f32 v161, v162, v163
    v_mfma_f32_32x32x16_bf16 v[176:191], v[132:135], v[44:47], v[176:191]
    v_mul_f32 v164, v2, v164
    v_mul_f32 v165, v2, v165
    v_cvt_pk_bf16_f32 v162, v164, v165
    v_mul_f32 v166, v2, v166
    v_mul_f32 v167, v2, v167
    v_cvt_pk_bf16_f32 v163, v166, v167
    v_mfma_f32_32x32x16_bf16 v[176:191], v[136:139], v[48:51], v[176:191]
    v_mul_f32 v168, v2, v168
    v_mul_f32 v169, v2, v169
    v_cvt_pk_bf16_f32 v164, v168, v169
    v_mul_f32 v170, v2, v170
    v_mul_f32 v171, v2, v171
    v_cvt_pk_bf16_f32 v165, v170, v171
    v_mfma_f32_32x32x16_bf16 v[176:191], v[140:143], v[52:55], v[176:191]
    v_mul_f32 v172, v2, v172
    v_mul_f32 v173, v2, v173
    v_cvt_pk_bf16_f32 v166, v172, v173
    v_mul_f32 v174, v2, v174
    v_mul_f32 v175, v2, v175
    v_cvt_pk_bf16_f32 v167, v174, v175
    v_mfma_f32_32x32x16_bf16 v[192:207], v[144:147], v[32:35], 0
    ds_write_b64 v28, v[160:161] offset:0
    ds_write_b64 v28, v[162:163] offset:16
    ds_write_b64 v28, v[164:165] offset:32
    ds_write_b64 v28, v[166:167] offset:48
    v_mfma_f32_32x32x16_bf16 v[192:207], v[148:151], v[36:39], v[192:207]
    v_mfma_f32_32x32x16_bf16 v[192:207], v[152:155], v[40:43], v[192:207]
    v_mul_f32 v176, v2, v176
    v_mul_f32 v177, v2, v177
    v_cvt_pk_bf16_f32 v176, v176, v177
    v_mul_f32 v178, v2, v178
    v_mul_f32 v179, v2, v179
    v_cvt_pk_bf16_f32 v177, v178, v179
    v_mfma_f32_32x32x16_bf16 v[192:207], v[156:159], v[44:47], v[192:207]
    v_mul_f32 v180, v2, v180
    v_mul_f32 v181, v2, v181
    v_cvt_pk_bf16_f32 v178, v180, v181
    v_mul_f32 v182, v2, v182
    v_mul_f32 v183, v2, v183
    v_cvt_pk_bf16_f32 v179, v182, v183
    v_mfma_f32_32x32x16_bf16 v[192:207], a[244:247], v[48:51], v[192:207]
    v_mul_f32 v184, v2, v184
    v_mul_f32 v185, v2, v185
    v_cvt_pk_bf16_f32 v180, v184, v185
    v_mul_f32 v186, v2, v186
    v_mul_f32 v187, v2, v187
    v_cvt_pk_bf16_f32 v181, v186, v187
    v_mfma_f32_32x32x16_bf16 v[192:207], a[248:251], v[52:55], v[192:207]
    v_mul_f32 v188, v2, v188
    v_mul_f32 v189, v2, v189
    v_cvt_pk_bf16_f32 v182, v188, v189
    v_mul_f32 v190, v2, v190
    v_mul_f32 v191, v2, v191
    v_cvt_pk_bf16_f32 v183, v190, v191
    ds_write_b64 v28, v[176:177] offset:64
    ds_write_b64 v28, v[178:179] offset:80
    ds_write_b64 v28, v[180:181] offset:96
    ds_write_b64 v28, v[182:183] offset:112
    s_nop 7
    v_pk_mul_f32 v[192:193], v[192:193], v[2:3]
    v_pk_mul_f32 v[194:195], v[194:195], v[2:3]
    v_pk_mul_f32 v[196:197], v[196:197], v[2:3]
    v_pk_mul_f32 v[198:199], v[198:199], v[2:3]
    v_pk_mul_f32 v[200:201], v[200:201], v[2:3]
    v_pk_mul_f32 v[202:203], v[202:203], v[2:3]
    v_pk_mul_f32 v[204:205], v[204:205], v[2:3]
    v_pk_mul_f32 v[206:207], v[206:207], v[2:3]
    v_cvt_pk_bf16_f32 v192, v192, v193
    v_cvt_pk_bf16_f32 v193, v194, v195
    v_cvt_pk_bf16_f32 v194, v196, v197
    v_cvt_pk_bf16_f32 v195, v198, v199
    v_cvt_pk_bf16_f32 v196, v200, v201
    v_cvt_pk_bf16_f32 v197, v202, v203
    v_cvt_pk_bf16_f32 v198, v204, v205
    v_cvt_pk_bf16_f32 v199, v206, v207
    ds_write_b64 v28, v[192:193] offset:128
    ds_write_b64 v28, v[194:195] offset:144
    ds_write_b64 v28, v[196:197] offset:160
    ds_write_b64 v28, v[198:199] offset:176
    s_waitcnt lgkmcnt(0)
    ds_read_b128 v[64:67], v25 offset:0
    ds_read_b128 v[68:71], v26 offset:0
    ds_read_b128 v[72:75], v27 offset:0
    ds_read_b128 v[76:79], v25 offset:3328
    ds_read_b128 v[80:83], v26 offset:3328
    ds_read_b128 v[84:87], v27 offset:3328
    s_add_u32 s60, s37, 4096
    s_waitcnt lgkmcnt(5)
    buffer_store_dwordx4 v[64:67], v16, s[20:23], s37 offen offset:0 nt
    s_waitcnt lgkmcnt(4)
    buffer_store_dwordx4 v[68:71], v16, s[20:23], s37 offen offset:1024 nt
    s_waitcnt lgkmcnt(3)
    buffer_store_dwordx4 v[72:75], v16, s[20:23], s37 offen offset:2048 nt
    s_waitcnt lgkmcnt(2)
    buffer_store_dwordx4 v[76:79], v16, s[20:23], s37 offen offset:3072 nt
    s_waitcnt lgkmcnt(1)
    buffer_store_dwordx4 v[80:83], v16, s[20:23], s60 offen offset:0 nt
    s_waitcnt lgkmcnt(0)
    buffer_store_dwordx4 v[84:87], v16, s[20:23], s60 offen offset:1024 nt
    s_endpgm
L_owner:
    s_waitcnt lgkmcnt(0)
    v_mfma_f32_32x32x16_bf16 v[32:47], a[192:195], a[96:99], v[96:111]
    v_mfma_f32_32x32x16_bf16 v[32:47], a[196:199], a[100:103], v[32:47]
    v_mfma_f32_32x32x16_bf16 v[32:47], a[200:203], a[104:107], v[32:47]
    v_mfma_f32_32x32x16_bf16 v[32:47], a[204:207], a[108:111], v[32:47]
    v_mfma_f32_32x32x16_bf16 v[32:47], a[208:211], a[112:115], v[32:47]
    v_mfma_f32_32x32x16_bf16 v[32:47], a[212:215], a[116:119], v[32:47]
    s_waitcnt lgkmcnt(0)
    s_nop 9
.p2align 6
L_loop_o:
    v_mfma_f32_32x32x16_bf16 v[48:63], a[192:195], a[120:123], v[112:127]
    s_cmp_lt_u32 s28, 5
    ds_read_b128 a[192:195], v13 offset:0
    v_exp_f32 v32, v32
    v_exp_f32 v33, v33
    v_add_f32 v17, v17, v32
    v_mfma_f32_32x32x16_bf16 v[48:63], a[196:199], a[124:127], v[48:63]
    s_cselect_b32 s36, 0, s43
    ds_read_b128 a[196:199], v13 offset:2176
    v_exp_f32 v34, v34
    v_exp_f32 v35, v35
    v_add_f32 v17, v17, v33
    v_mfma_f32_32x32x16_bf16 v[48:63], a[200:203], a[128:131], v[48:63]
    s_cselect_b32 s35, s29, 0x30000
    ds_read_b128 a[200:203], v13 offset:512
    v_cvt_pk_bf16_f32 v32, v32, v33
    v_exp_f32 v36, v36
    v_add_f32 v17, v17, v34
    v_add_f32 v17, v17, v35
    v_mfma_f32_32x32x16_bf16 v[48:63], a[204:207], a[132:135], v[48:63]
    s_sub_u32 s42, s33, s36
    ds_read_b128 a[204:207], v13 offset:2688
    v_exp_f32 v37, v37
    v_cvt_pk_bf16_f32 v33, v34, v35
    v_exp_f32 v38, v38
    v_mfma_f32_32x32x16_bf16 v[48:63], a[208:211], a[136:139], v[48:63]
    s_add_u32 s29, s29, s34
    ds_read_b128 a[208:211], v13 offset:4352
    v_add_f32 v17, v17, v36
    v_exp_f32 v39, v39
    v_add_f32 v17, v17, v37
    v_cvt_pk_bf16_f32 v34, v36, v37
    v_mfma_f32_32x32x16_bf16 v[48:63], a[212:215], a[140:143], v[48:63]
    s_waitcnt lgkmcnt(5)
    ds_read_b128 a[212:215], v13 offset:4864
    v_exp_f32 v40, v40
    v_add_f32 v17, v17, v38
    v_exp_f32 v41, v41
    v_mfma_f32_32x32x16_bf16 v[160:175], a[216:219], v[80:83], v[160:175]
    ds_read_b64_tr_b16 a[216:217], v4 offset:0
    ds_read_b64_tr_b16 a[218:219], v4 offset:128
    v_add_f32 v17, v17, v39
    v_cvt_pk_bf16_f32 v35, v38, v39
    v_exp_f32 v42, v42
    v_mfma_f32_32x32x16_bf16 v[176:191], a[220:223], v[80:83], v[176:191]
    ds_read_b64_tr_b16 a[220:221], v4 offset:512
    ds_read_b64_tr_b16 a[222:223], v4 offset:640
    v_add_f32 v17, v17, v40
    v_exp_f32 v43, v43
    v_add_f32 v17, v17, v41
    v_mfma_f32_32x32x16_bf16 v[192:207], a[224:227], v[80:83], v[192:207]
    ds_read_b64_tr_b16 a[224:225], v8 offset:4352
    ds_read_b64_tr_b16 a[226:227], v8 offset:4480
    v_cvt_pk_bf16_f32 v40, v40, v41
    v_exp_f32 v44, v44
    v_add_f32 v17, v17, v42
    v_mfma_f32_32x32x16_bf16 v[160:175], a[228:231], v[88:91], v[160:175]
    ds_read_b64_tr_b16 a[228:229], v4 offset:256
    ds_read_b64_tr_b16 a[230:231], v4 offset:384
    v_exp_f32 v45, v45
    v_add_f32 v17, v17, v43
    v_cvt_pk_bf16_f32 v41, v42, v43
    v_mfma_f32_32x32x16_bf16 v[176:191], a[232:235], v[88:91], v[176:191]
    ds_read_b64_tr_b16 a[232:233], v4 offset:768
    ds_read_b64_tr_b16 a[234:235], v4 offset:896
    v_exp_f32 v46, v46
    v_add_f32 v17, v17, v44
    v_add_f32 v17, v17, v45
    v_mfma_f32_32x32x16_bf16 v[192:207], a[236:239], v[88:91], v[192:207]
    s_waitcnt lgkmcnt(10)
    ds_read_b64_tr_b16 a[236:237], v8 offset:4608
    ds_read_b64_tr_b16 a[238:239], v8 offset:4736
    v_exp_f32 v47, v47
    v_cvt_pk_bf16_f32 v42, v44, v45
    v_add_f32 v17, v17, v46
    v_mfma_f32_32x32x16_bf16 v[64:79], a[192:195], a[96:99], v[96:111]
    buffer_load_dwordx2 v[22:23], v11, s[24:27], s41 offen sc1
    v_add_f32 v17, v17, v47
    v_cvt_pk_bf16_f32 v43, v46, v47
    v_exp_f32 v48, v48
    v_mfma_f32_32x32x16_bf16 v[64:79], a[196:199], a[100:103], v[64:79]
    v_exp_f32 v49, v49
    v_exp_f32 v50, v50
    v_add_f32 v18, v18, v48
    v_add_f32 v18, v18, v49
    v_mfma_f32_32x32x16_bf16 v[64:79], a[200:203], a[104:107], v[64:79]
    v_exp_f32 v51, v51
    v_cvt_pk_bf16_f32 v48, v48, v49
    v_exp_f32 v52, v52
    v_add_f32 v18, v18, v50
    v_mfma_f32_32x32x16_bf16 v[64:79], a[204:207], a[108:111], v[64:79]
    v_exp_f32 v53, v53
    v_add_f32 v18, v18, v51
    v_cvt_pk_bf16_f32 v49, v50, v51
    v_exp_f32 v54, v54
    v_mfma_f32_32x32x16_bf16 v[64:79], a[208:211], a[112:115], v[64:79]
    v_add_f32 v18, v18, v52
    v_exp_f32 v55, v55
    v_add_f32 v18, v18, v53
    v_cvt_pk_bf16_f32 v50, v52, v53
    v_mfma_f32_32x32x16_bf16 v[64:79], a[212:215], a[116:119], v[64:79]
    s_waitcnt lgkmcnt(0)
    v_exp_f32 v56, v56
    v_add_f32 v18, v18, v54
    v_exp_f32 v57, v57
    v_mfma_f32_32x32x16_bf16 v[160:175], a[216:219], v[32:35], v[160:175]
    v_add_f32 v18, v18, v55
    v_cvt_pk_bf16_f32 v51, v54, v55
    v_exp_f32 v58, v58
    v_add_f32 v18, v18, v56
    v_add_f32 v18, v18, v57
    v_mfma_f32_32x32x16_bf16 v[176:191], a[220:223], v[32:35], v[176:191]
    v_exp_f32 v59, v59
    v_cvt_pk_bf16_f32 v56, v56, v57
    v_exp_f32 v60, v60
    v_mfma_f32_32x32x16_bf16 v[192:207], a[224:227], v[32:35], v[192:207]
    v_add_f32 v18, v18, v58
    v_exp_f32 v61, v61
    v_add_f32 v18, v18, v59
    v_cvt_pk_bf16_f32 v57, v58, v59
    v_mfma_f32_32x32x16_bf16 v[160:175], a[228:231], v[40:43], v[160:175]
    v_exp_f32 v62, v62
    v_add_f32 v18, v18, v60
    v_exp_f32 v63, v63
    v_add_f32 v18, v18, v61
    v_mfma_f32_32x32x16_bf16 v[176:191], a[232:235], v[40:43], v[176:191]
    v_cvt_pk_bf16_f32 v58, v60, v61
    v_add_f32 v18, v18, v62
    v_add_f32 v18, v18, v63
    v_cvt_pk_bf16_f32 v59, v62, v63
    v_add_u32 v13, s33, v13
    v_mfma_f32_32x32x16_bf16 v[192:207], a[236:239], v[40:43], v[192:207]
    v_add_u32 v4, s42, v4
    v_add_u32 v8, s42, v8
    v_add_u32 v7, s34, v7
    v_add_u32 v30, s34, v30
    v_add_u32 v12, s42, v12
    v_mfma_f32_32x32x16_bf16 v[32:47], a[192:195], a[120:123], v[112:127]
    ds_read_b128 a[192:195], v14 offset:0
    v_exp_f32 v64, v64
    v_exp_f32 v65, v65
    v_add_f32 v17, v17, v64
    v_mfma_f32_32x32x16_bf16 v[32:47], a[196:199], a[124:127], v[32:47]
    ds_read_b128 a[196:199], v14 offset:2176
    v_exp_f32 v66, v66
    v_exp_f32 v67, v67
    v_add_f32 v17, v17, v65
    v_mfma_f32_32x32x16_bf16 v[32:47], a[200:203], a[128:131], v[32:47]
    ds_read_b128 a[200:203], v14 offset:512
    v_cvt_pk_bf16_f32 v64, v64, v65
    v_exp_f32 v68, v68
    v_add_f32 v17, v17, v66
    v_add_f32 v17, v17, v67
    v_mfma_f32_32x32x16_bf16 v[32:47], a[204:207], a[132:135], v[32:47]
    ds_read_b128 a[204:207], v14 offset:2688
    v_exp_f32 v69, v69
    v_cvt_pk_bf16_f32 v65, v66, v67
    v_exp_f32 v70, v70
    v_mfma_f32_32x32x16_bf16 v[32:47], a[208:211], a[136:139], v[32:47]
    ds_read_b128 a[208:211], v14 offset:4352
    v_add_f32 v17, v17, v68
    v_exp_f32 v71, v71
    v_add_f32 v17, v17, v69
    v_cvt_pk_bf16_f32 v66, v68, v69
    v_mfma_f32_32x32x16_bf16 v[32:47], a[212:215], a[140:143], v[32:47]
    ds_read_b128 a[212:215], v14 offset:4864
    v_exp_f32 v72, v72
    v_add_f32 v17, v17, v70
    v_exp_f32 v73, v73
    v_mfma_f32_32x32x16_bf16 v[208:223], a[216:219], v[48:51], v[208:223]
    ds_read_b64_tr_b16 a[216:217], v5 offset:0
    ds_read_b64_tr_b16 a[218:219], v5 offset:128
    v_add_f32 v17, v17, v71
    v_cvt_pk_bf16_f32 v67, v70, v71
    v_exp_f32 v74, v74
    v_mfma_f32_32x32x16_bf16 v[224:239], a[220:223], v[48:51], v[224:239]
    ds_read_b64_tr_b16 a[220:221], v5 offset:512
    ds_read_b64_tr_b16 a[222:223], v5 offset:640
    v_add_f32 v17, v17, v72
    v_exp_f32 v75, v75
    v_add_f32 v17, v17, v73
    v_mfma_f32_32x32x16_bf16 v[240:255], a[224:227], v[48:51], v[240:255]
    ds_read_b64_tr_b16 a[224:225], v10 offset:4352
    ds_read_b64_tr_b16 a[226:227], v10 offset:4480
    v_cvt_pk_bf16_f32 v72, v72, v73
    v_exp_f32 v76, v76
    v_add_f32 v17, v17, v74
    v_mfma_f32_32x32x16_bf16 v[208:223], a[228:231], v[56:59], v[208:223]
    ds_read_b64_tr_b16 a[228:229], v5 offset:256
    ds_read_b64_tr_b16 a[230:231], v5 offset:384
    v_exp_f32 v77, v77
    v_add_f32 v17, v17, v75
    v_cvt_pk_bf16_f32 v73, v74, v75
    v_mfma_f32_32x32x16_bf16 v[224:239], a[232:235], v[56:59], v[224:239]
    ds_read_b64_tr_b16 a[232:233], v5 offset:768
    ds_read_b64_tr_b16 a[234:235], v5 offset:896
    v_exp_f32 v78, v78
    v_add_f32 v17, v17, v76
    v_add_f32 v17, v17, v77
    v_mfma_f32_32x32x16_bf16 v[240:255], a[236:239], v[56:59], v[240:255]
    s_waitcnt lgkmcnt(10)
    ds_read_b64_tr_b16 a[236:237], v10 offset:4608
    ds_read_b64_tr_b16 a[238:239], v10 offset:4736
    v_exp_f32 v79, v79
    v_cvt_pk_bf16_f32 v74, v76, v77
    v_add_f32 v17, v17, v78
    v_mfma_f32_32x32x16_bf16 v[48:63], a[192:195], a[96:99], v[96:111]
    s_waitcnt vmcnt(0)
    s_barrier
    v_add_f32 v17, v17, v79
    v_cvt_pk_bf16_f32 v75, v78, v79
    v_exp_f32 v32, v32
    v_mfma_f32_32x32x16_bf16 v[48:63], a[196:199], a[100:103], v[48:63]
    v_cmp_ne_u64 vcc, s[4:5], v[22:23]
    v_exp_f32 v33, v33
    v_exp_f32 v34, v34
    v_add_f32 v18, v18, v32
    v_mfma_f32_32x32x16_bf16 v[48:63], a[200:203], a[104:107], v[48:63]
    s_mov_b32 m0, s35
    v_exp_f32 v35, v35
    v_add_f32 v18, v18, v33
    v_cvt_pk_bf16_f32 v32, v32, v33
    v_exp_f32 v36, v36
    v_mfma_f32_32x32x16_bf16 v[48:63], a[204:207], a[108:111], v[48:63]
    s_cbranch_vccnz L_slow_o
L_back_o:
    v_add_f32 v18, v18, v34
    v_exp_f32 v37, v37
    v_add_f32 v18, v18, v35
    v_cvt_pk_bf16_f32 v33, v34, v35
    v_add_f32 v18, v18, v36
    v_mfma_f32_32x32x16_bf16 v[48:63], a[208:211], a[112:115], v[48:63]
    buffer_load_dwordx4 v16, s[24:27], s30 offen offset:0 sc1 lds
    v_exp_f32 v38, v38
    v_exp_f32 v39, v39
    v_add_f32 v18, v18, v37
    v_mfma_f32_32x32x16_bf16 v[48:63], a[212:215], a[116:119], v[48:63]
    s_waitcnt lgkmcnt(0)
    v_cvt_pk_bf16_f32 v34, v36, v37
    v_exp_f32 v40, v40
    v_add_f32 v18, v18, v38
    v_exp_f32 v41, v41
    v_mfma_f32_32x32x16_bf16 v[160:175], a[216:219], v[64:67], v[160:175]
    buffer_load_dwordx4 v16, s[24:27], s30 offen offset:1088 sc1 lds
    v_add_f32 v18, v18, v39
    v_cvt_pk_bf16_f32 v35, v38, v39
    v_exp_f32 v42, v42
    v_mfma_f32_32x32x16_bf16 v[176:191], a[220:223], v[64:67], v[176:191]
    buffer_load_dwordx4 v16, s[24:27], s30 offen offset:2176 sc1 lds
    v_add_f32 v18, v18, v40
    v_exp_f32 v43, v43
    v_add_f32 v18, v18, v41
    v_mfma_f32_32x32x16_bf16 v[192:207], a[224:227], v[64:67], v[192:207]
    buffer_load_dwordx4 v16, s[24:27], s30 offen offset:3264 sc1 lds
    v_cvt_pk_bf16_f32 v40, v40, v41
    v_exp_f32 v44, v44
    v_add_f32 v18, v18, v42
    v_add_f32 v18, v18, v43
    v_mfma_f32_32x32x16_bf16 v[160:175], a[228:231], v[72:75], v[160:175]
    s_add_u32 m0, s35, 4352
    v_exp_f32 v45, v45
    v_cvt_pk_bf16_f32 v41, v42, v43
    v_exp_f32 v46, v46
    v_mfma_f32_32x32x16_bf16 v[176:191], a[232:235], v[72:75], v[176:191]
    buffer_load_dwordx4 v16, s[24:27], s31 offen offset:0 sc1 lds
    v_add_f32 v18, v18, v44
    v_exp_f32 v47, v47
    v_add_f32 v18, v18, v45
    v_cvt_pk_bf16_f32 v42, v44, v45
    v_mfma_f32_32x32x16_bf16 v[192:207], a[236:239], v[72:75], v[192:207]
    buffer_load_dwordx4 v16, s[24:27], s31 offen offset:1088 sc1 lds
    v_add_f32 v18, v18, v46
    v_add_f32 v18, v18, v47
    v_cvt_pk_bf16_f32 v43, v46, v47
    v_add_u32 v14, s33, v14
    v_mfma_f32_32x32x16_bf16 v[64:79], a[192:195], a[120:123], v[112:127]
    s_add_u32 s41, s41, 512
    ds_read_b128 a[192:195], v15 offset:0
    v_exp_f32 v48, v48
    v_exp_f32 v49, v49
    v_add_f32 v17, v17, v48
    v_mfma_f32_32x32x16_bf16 v[64:79], a[196:199], a[124:127], v[64:79]
    s_min_u32 s41, s41, s61
    ds_read_b128 a[196:199], v15 offset:2176
    v_exp_f32 v50, v50
    v_exp_f32 v51, v51
    v_add_f32 v17, v17, v49
    v_mfma_f32_32x32x16_bf16 v[64:79], a[200:203], a[128:131], v[64:79]
    s_add_u32 s30, s30, 26112
    ds_read_b128 a[200:203], v15 offset:512
    v_cvt_pk_bf16_f32 v48, v48, v49
    v_exp_f32 v52, v52
    v_add_f32 v17, v17, v50
    v_add_f32 v17, v17, v51
    v_mfma_f32_32x32x16_bf16 v[64:79], a[204:207], a[132:135], v[64:79]
    s_add_u32 s31, s31, 26112
    ds_read_b128 a[204:207], v15 offset:2688
    v_exp_f32 v53, v53
    v_cvt_pk_bf16_f32 v49, v50, v51
    v_exp_f32 v54, v54
    v_mfma_f32_32x32x16_bf16 v[64:79], a[208:211], a[136:139], v[64:79]
    ds_read_b128 a[208:211], v15 offset:4352
    v_add_f32 v17, v17, v52
    v_exp_f32 v55, v55
    v_add_f32 v17, v17, v53
    v_cvt_pk_bf16_f32 v50, v52, v53
    v_mfma_f32_32x32x16_bf16 v[64:79], a[212:215], a[140:143], v[64:79]
    ds_read_b128 a[212:215], v15 offset:4864
    v_exp_f32 v56, v56
    v_add_f32 v17, v17, v54
    v_exp_f32 v57, v57
    v_mfma_f32_32x32x16_bf16 v[208:223], a[216:219], v[32:35], v[208:223]
    ds_read_b64_tr_b16 a[216:217], v6 offset:0
    ds_read_b64_tr_b16 a[218:219], v6 offset:128
    v_add_f32 v17, v17, v55
    v_cvt_pk_bf16_f32 v51, v54, v55
    v_exp_f32 v58, v58
    v_mfma_f32_32x32x16_bf16 v[224:239], a[220:223], v[32:35], v[224:239]
    ds_read_b64_tr_b16 a[220:221], v6 offset:512
    ds_read_b64_tr_b16 a[222:223], v6 offset:640
    v_add_f32 v17, v17, v56
    v_exp_f32 v59, v59
    v_add_f32 v17, v17, v57
    v_mfma_f32_32x32x16_bf16 v[240:255], a[224:227], v[32:35], v[240:255]
    ds_read_b64_tr_b16 a[224:225], v29 offset:4352
    ds_read_b64_tr_b16 a[226:227], v29 offset:4480
    v_cvt_pk_bf16_f32 v56, v56, v57
    v_exp_f32 v60, v60
    v_add_f32 v17, v17, v58
    v_mfma_f32_32x32x16_bf16 v[208:223], a[228:231], v[40:43], v[208:223]
    ds_read_b64_tr_b16 a[228:229], v6 offset:256
    ds_read_b64_tr_b16 a[230:231], v6 offset:384
    v_exp_f32 v61, v61
    v_add_f32 v17, v17, v59
    v_cvt_pk_bf16_f32 v57, v58, v59
    v_mfma_f32_32x32x16_bf16 v[224:239], a[232:235], v[40:43], v[224:239]
    ds_read_b64_tr_b16 a[232:233], v6 offset:768
    ds_read_b64_tr_b16 a[234:235], v6 offset:896
    v_exp_f32 v62, v62
    v_add_f32 v17, v17, v60
    v_add_f32 v17, v17, v61
    v_mfma_f32_32x32x16_bf16 v[240:255], a[236:239], v[40:43], v[240:255]
    s_waitcnt lgkmcnt(10)
    ds_read_b64_tr_b16 a[236:237], v29 offset:4608
    ds_read_b64_tr_b16 a[238:239], v29 offset:4736
    v_exp_f32 v63, v63
    v_cvt_pk_bf16_f32 v58, v60, v61
    v_add_f32 v17, v17, v62
    v_mfma_f32_32x32x16_bf16 v[80:95], a[192:195], a[96:99], v[96:111]
    ds_read_b128 a[192:195], v12 offset:0
    v_add_f32 v17, v17, v63
    v_cvt_pk_bf16_f32 v59, v62, v63
    v_exp_f32 v64, v64
    v_mfma_f32_32x32x16_bf16 v[80:95], a[196:199], a[100:103], v[80:95]
    ds_read_b128 a[196:199], v12 offset:2176
    v_exp_f32 v65, v65
    v_exp_f32 v66, v66
    v_add_f32 v18, v18, v64
    v_mfma_f32_32x32x16_bf16 v[80:95], a[200:203], a[104:107], v[80:95]
    ds_read_b128 a[200:203], v12 offset:512
    v_exp_f32 v67, v67
    v_add_f32 v18, v18, v65
    v_cvt_pk_bf16_f32 v64, v64, v65
    v_add_f32 v18, v18, v66
    v_mfma_f32_32x32x16_bf16 v[80:95], a[204:207], a[108:111], v[80:95]
    ds_read_b128 a[204:207], v12 offset:2688
    v_exp_f32 v68, v68
    v_exp_f32 v69, v69
    v_add_f32 v18, v18, v67
    v_mfma_f32_32x32x16_bf16 v[80:95], a[208:211], a[112:115], v[80:95]
    ds_read_b128 a[208:211], v12 offset:4352
    v_cvt_pk_bf16_f32 v65, v66, v67
    v_exp_f32 v70, v70
    v_add_f32 v18, v18, v68
    v_add_f32 v18, v18, v69
    v_mfma_f32_32x32x16_bf16 v[80:95], a[212:215], a[116:119], v[80:95]
    s_waitcnt lgkmcnt(5)
    ds_read_b128 a[212:215], v12 offset:4864
    v_exp_f32 v71, v71
    v_cvt_pk_bf16_f32 v66, v68, v69
    v_exp_f32 v72, v72
    v_mfma_f32_32x32x16_bf16 v[160:175], a[216:219], v[48:51], v[160:175]
    v_add_f32 v18, v18, v70
    v_exp_f32 v73, v73
    v_add_f32 v18, v18, v71
    v_cvt_pk_bf16_f32 v67, v70, v71
    v_add_f32 v18, v18, v72
    v_mfma_f32_32x32x16_bf16 v[176:191], a[220:223], v[48:51], v[176:191]
    v_exp_f32 v74, v74
    v_exp_f32 v75, v75
    v_add_f32 v18, v18, v73
    v_cvt_pk_bf16_f32 v72, v72, v73
    v_mfma_f32_32x32x16_bf16 v[192:207], a[224:227], v[48:51], v[192:207]
    v_exp_f32 v76, v76
    v_add_f32 v18, v18, v74
    v_exp_f32 v77, v77
    v_add_f32 v18, v18, v75
    v_mfma_f32_32x32x16_bf16 v[160:175], a[228:231], v[56:59], v[160:175]
    v_cvt_pk_bf16_f32 v73, v74, v75
    v_exp_f32 v78, v78
    v_add_f32 v18, v18, v76
    v_exp_f32 v79, v79
    v_mfma_f32_32x32x16_bf16 v[176:191], a[232:235], v[56:59], v[176:191]
    v_add_f32 v18, v18, v77
    v_cvt_pk_bf16_f32 v74, v76, v77
    v_add_f32 v18, v18, v78
    v_add_f32 v18, v18, v79
    v_cvt_pk_bf16_f32 v75, v78, v79
    v_mfma_f32_32x32x16_bf16 v[192:207], a[236:239], v[56:59], v[192:207]
    s_waitcnt lgkmcnt(0)
    v_add_u32 v5, s33, v5
    v_add_u32 v10, s33, v10
    v_add_u32 v15, s33, v15
    v_add_u32 v6, s33, v6
    v_add_u32 v29, s33, v29
    v_mfma_f32_32x32x16_bf16 v[32:47], a[192:195], a[96:99], v[96:111]
    v_exp_f32 v80, v80
    v_exp_f32 v81, v81
    v_exp_f32 v82, v82
    v_mfma_f32_32x32x16_bf16 v[32:47], a[196:199], a[100:103], v[32:47]
    s_add_u32 s36, s33, s34
    v_add_f32 v17, v17, v80
    v_exp_f32 v83, v83
    v_add_f32 v17, v17, v81
    v_cvt_pk_bf16_f32 v80, v80, v81
    v_add_f32 v17, v17, v82
    v_mfma_f32_32x32x16_bf16 v[32:47], a[200:203], a[104:107], v[32:47]
    s_mov_b32 s34, s33
    v_exp_f32 v84, v84
    v_exp_f32 v85, v85
    v_add_f32 v17, v17, v83
    v_cvt_pk_bf16_f32 v81, v82, v83
    v_mfma_f32_32x32x16_bf16 v[32:47], a[204:207], a[108:111], v[32:47]
    s_sub_u32 s33, 0, s36
    v_exp_f32 v86, v86
    v_add_f32 v17, v17, v84
    v_exp_f32 v87, v87
    v_add_f32 v17, v17, v85
    v_mfma_f32_32x32x16_bf16 v[32:47], a[208:211], a[112:115], v[32:47]
    s_add_u32 s28, s28, 1
    v_cvt_pk_bf16_f32 v82, v84, v85
    v_exp_f32 v88, v88
    v_add_f32 v17, v17, v86
    v_exp_f32 v89, v89
    v_mfma_f32_32x32x16_bf16 v[32:47], a[212:215], a[116:119], v[32:47]
    s_cmp_lt_u32 s28, 6
    v_add_f32 v17, v17, v87
    v_cvt_pk_bf16_f32 v83, v86, v87
    v_exp_f32 v90, v90
    v_add_f32 v17, v17, v88
    v_add_f32 v17, v17, v89
    v_mfma_f32_32x32x16_bf16 v[208:223], a[216:219], v[64:67], v[208:223]
    ds_read_b64_tr_b16 a[216:217], v7 offset:0
    ds_read_b64_tr_b16 a[218:219], v7 offset:128
    v_exp_f32 v91, v91
    v_cvt_pk_bf16_f32 v88, v88, v89
    v_mfma_f32_32x32x16_bf16 v[224:239], a[220:223], v[64:67], v[224:239]
    ds_read_b64_tr_b16 a[220:221], v7 offset:512
    ds_read_b64_tr_b16 a[222:223], v7 offset:640
    v_exp_f32 v92, v92
    v_add_f32 v17, v17, v90
    v_mfma_f32_32x32x16_bf16 v[240:255], a[224:227], v[64:67], v[240:255]
    ds_read_b64_tr_b16 a[224:225], v30 offset:4352
    ds_read_b64_tr_b16 a[226:227], v30 offset:4480
    v_exp_f32 v93, v93
    v_add_f32 v17, v17, v91
    v_cvt_pk_bf16_f32 v89, v90, v91
    v_mfma_f32_32x32x16_bf16 v[208:223], a[228:231], v[72:75], v[208:223]
    ds_read_b64_tr_b16 a[228:229], v7 offset:256
    ds_read_b64_tr_b16 a[230:231], v7 offset:384
    v_exp_f32 v94, v94
    v_add_f32 v17, v17, v92
    v_mfma_f32_32x32x16_bf16 v[224:239], a[232:235], v[72:75], v[224:239]
    ds_read_b64_tr_b16 a[232:233], v7 offset:768
    ds_read_b64_tr_b16 a[234:235], v7 offset:896
    v_exp_f32 v95, v95
    v_add_f32 v17, v17, v93
    v_mfma_f32_32x32x16_bf16 v[240:255], a[236:239], v[72:75], v[240:255]
    ds_read_b64_tr_b16 a[236:237], v30 offset:4608
    ds_read_b64_tr_b16 a[238:239], v30 offset:4736
    v_cvt_pk_bf16_f32 v90, v92, v93
    v_add_f32 v17, v17, v94
    v_add_f32 v17, v17, v95
    v_cvt_pk_bf16_f32 v91, v94, v95
    s_cbranch_scc1 L_loop_o
    s_mul_i32 s60, s14, 12544
    s_add_u32 s60, s60, 78336
    v_add_u32 v6, s60, v16
    v_lshlrev_b32 v7, 2, v1
    v_add_u32 v7, s60, v7
    s_mov_b32 s58, 0x12800000
    s_waitcnt lgkmcnt(0)
    v_mfma_f32_32x32x16_bf16 v[48:63], a[192:195], a[120:123], v[112:127]
    ds_read_b128 v[96:99], v16 offset:6528
    ds_read_b128 v[100:103], v16 offset:7616
    ds_read_b128 v[104:107], v16 offset:8704
    ds_read_b128 v[108:111], v16 offset:9792
    ds_read_b128 v[128:131], v16 offset:15232
    ds_read_b128 v[132:135], v16 offset:16320
    v_mfma_f32_32x32x16_bf16 v[48:63], a[196:199], a[124:127], v[48:63]
    ds_read_b128 v[112:115], v16 offset:10880
    ds_read_b128 v[116:119], v16 offset:11968
    ds_read_b128 v[120:123], v16 offset:13056
    ds_read_b128 v[124:127], v16 offset:14144
    ds_read_b128 v[136:139], v16 offset:17408
    ds_read_b128 v[140:143], v16 offset:18496
    v_mfma_f32_32x32x16_bf16 v[48:63], a[200:203], a[128:131], v[48:63]
    ds_read_b128 v[144:147], v16 offset:19584
    ds_read_b128 v[148:151], v16 offset:20672
    ds_read_b128 v[152:155], v16 offset:21760
    ds_read_b128 v[156:159], v16 offset:22848
    ds_read_b128 a[244:247], v16 offset:23936
    ds_read_b128 a[248:251], v16 offset:25024
    v_mfma_f32_32x32x16_bf16 v[48:63], a[204:207], a[132:135], v[48:63]
    v_exp_f32 v32, v32
    v_exp_f32 v33, v33
    v_exp_f32 v34, v34
    v_mfma_f32_32x32x16_bf16 v[48:63], a[208:211], a[136:139], v[48:63]
    v_exp_f32 v35, v35
    v_exp_f32 v36, v36
    v_exp_f32 v37, v37
    v_mfma_f32_32x32x16_bf16 v[48:63], a[212:215], a[140:143], v[48:63]
    v_exp_f32 v38, v38
    v_exp_f32 v39, v39
    v_add_f32 v17, v17, v32
    v_mfma_f32_32x32x16_bf16 v[160:175], a[216:219], v[80:83], v[160:175]
    ds_read_b64_tr_b16 a[216:217], v4 offset:0
    ds_read_b64_tr_b16 a[218:219], v4 offset:128
    v_add_f32 v17, v17, v33
    v_add_f32 v17, v17, v34
    v_add_f32 v17, v17, v35
    v_add_f32 v17, v17, v36
    v_mfma_f32_32x32x16_bf16 v[176:191], a[220:223], v[80:83], v[176:191]
    ds_read_b64_tr_b16 a[220:221], v4 offset:512
    ds_read_b64_tr_b16 a[222:223], v4 offset:640
    v_add_f32 v17, v17, v37
    v_add_f32 v17, v17, v38
    v_add_f32 v17, v17, v39
    v_cvt_pk_bf16_f32 v32, v32, v33
    v_mfma_f32_32x32x16_bf16 v[192:207], a[224:227], v[80:83], v[192:207]
    ds_read_b64_tr_b16 a[224:225], v8 offset:4352
    ds_read_b64_tr_b16 a[226:227], v8 offset:4480
    v_cvt_pk_bf16_f32 v33, v34, v35
    v_cvt_pk_bf16_f32 v34, v36, v37
    v_cvt_pk_bf16_f32 v35, v38, v39
    v_mfma_f32_32x32x16_bf16 v[160:175], a[228:231], v[88:91], v[160:175]
    v_exp_f32 v48, v48
    v_exp_f32 v49, v49
    v_exp_f32 v50, v50
    v_mfma_f32_32x32x16_bf16 v[176:191], a[232:235], v[88:91], v[176:191]
    v_exp_f32 v51, v51
    v_exp_f32 v52, v52
    v_exp_f32 v53, v53
    v_mfma_f32_32x32x16_bf16 v[192:207], a[236:239], v[88:91], v[192:207]
    v_exp_f32 v54, v54
    v_exp_f32 v55, v55
    v_add_f32 v18, v18, v48
    v_add_f32 v18, v18, v49
    s_waitcnt lgkmcnt(0)
    v_mfma_f32_32x32x16_bf16 v[160:175], a[216:219], v[32:35], v[160:175]
    v_add_f32 v18, v18, v50
    v_add_f32 v18, v18, v51
    v_add_f32 v18, v18, v52
    v_add_f32 v18, v18, v53
    v_add_f32 v18, v18, v54
    v_add_f32 v18, v18, v55
    v_mfma_f32_32x32x16_bf16 v[176:191], a[220:223], v[32:35], v[176:191]
    v_cvt_pk_bf16_f32 v48, v48, v49
    v_cvt_pk_bf16_f32 v49, v50, v51
    v_cvt_pk_bf16_f32 v50, v52, v53
    v_cvt_pk_bf16_f32 v51, v54, v55
    v_mfma_f32_32x32x16_bf16 v[192:207], a[224:227], v[32:35], v[192:207]
    v_mfma_f32_32x32x16_bf16 v[208:223], a[216:219], v[48:51], v[208:223]
    v_mov_b32 v2, v17
    s_nop 1
    v_permlane32_swap_b32 v17, v2
    s_nop 0
    v_add_f32 v2, v17, v2
    v_med3_f32 v3, v2, s58, v9
    v_mfma_f32_32x32x16_bf16 v[224:239], a[220:223], v[48:51], v[224:239]
    v_cmp_neq_f32 vcc, v3, v2
    v_mfma_f32_32x32x16_bf16 v[240:255], a[224:227], v[48:51], v[240:255]
    s_cbranch_vccnz L_redo_oo
L_redone_oo:
    v_rcp_f32 v2, v2
    v_cvt_pk_bf16_f32 v32, v160, v161
    v_cvt_pk_bf16_f32 v33, v162, v163
    v_cvt_pk_bf16_f32 v34, v164, v165
    v_cvt_pk_bf16_f32 v35, v166, v167
    v_cvt_pk_bf16_f32 v36, v168, v169
    v_cvt_pk_bf16_f32 v37, v170, v171
    v_cvt_pk_bf16_f32 v38, v172, v173
    v_cvt_pk_bf16_f32 v39, v174, v175
    v_mov_b32 v3, v2
    v_mfma_f32_32x32x16_bf16 v[160:175], v[96:99], v[32:35], 0
    v_cvt_pk_bf16_f32 v40, v176, v177
    v_cvt_pk_bf16_f32 v41, v178, v179
    v_cvt_pk_bf16_f32 v42, v180, v181
    v_cvt_pk_bf16_f32 v43, v182, v183
    v_cvt_pk_bf16_f32 v44, v184, v185
    v_cvt_pk_bf16_f32 v45, v186, v187
    v_mfma_f32_32x32x16_bf16 v[160:175], v[100:103], v[36:39], v[160:175]
    v_cvt_pk_bf16_f32 v46, v188, v189
    v_cvt_pk_bf16_f32 v47, v190, v191
    v_cvt_pk_bf16_f32 v48, v192, v193
    v_cvt_pk_bf16_f32 v49, v194, v195
    v_cvt_pk_bf16_f32 v50, v196, v197
    v_cvt_pk_bf16_f32 v51, v198, v199
    v_mfma_f32_32x32x16_bf16 v[160:175], v[104:107], v[40:43], v[160:175]
    v_cvt_pk_bf16_f32 v52, v200, v201
    v_cvt_pk_bf16_f32 v53, v202, v203
    v_cvt_pk_bf16_f32 v54, v204, v205
    v_cvt_pk_bf16_f32 v55, v206, v207
    v_mfma_f32_32x32x16_bf16 v[160:175], v[108:111], v[44:47], v[160:175]
    v_mfma_f32_32x32x16_bf16 v[160:175], v[112:115], v[48:51], v[160:175]
    v_mfma_f32_32x32x16_bf16 v[160:175], v[116:119], v[52:55], v[160:175]
    v_mfma_f32_32x32x16_bf16 v[176:191], v[120:123], v[32:35], 0
    v_mfma_f32_32x32x16_bf16 v[176:191], v[124:127], v[36:39], v[176:191]
    v_mfma_f32_32x32x16_bf16 v[176:191], v[128:131], v[40:43], v[176:191]
    v_mul_f32 v160, v2, v160
    v_mul_f32 v161, v2, v161
    v_cvt_pk_bf16_f32 v160, v160, v161
    v_mul_f32 v162, v2, v162
    v_mul_f32 v163, v2, v163
    v_cvt_pk_bf16_f32 v161, v162, v163
    v_mfma_f32_32x32x16_bf16 v[176:191], v[132:135], v[44:47], v[176:191]
    v_mul_f32 v164, v2, v164
    v_mul_f32 v165, v2, v165
    v_cvt_pk_bf16_f32 v162, v164, v165
    v_mul_f32 v166, v2, v166
    v_mul_f32 v167, v2, v167
    v_cvt_pk_bf16_f32 v163, v166, v167
    v_mfma_f32_32x32x16_bf16 v[176:191], v[136:139], v[48:51], v[176:191]
    v_mul_f32 v168, v2, v168
    v_mul_f32 v169, v2, v169
    v_cvt_pk_bf16_f32 v164, v168, v169
    v_mul_f32 v170, v2, v170
    v_mul_f32 v171, v2, v171
    v_cvt_pk_bf16_f32 v165, v170, v171
    v_mfma_f32_32x32x16_bf16 v[176:191], v[140:143], v[52:55], v[176:191]
    v_mul_f32 v172, v2, v172
    v_mul_f32 v173, v2, v173
    v_cvt_pk_bf16_f32 v166, v172, v173
    v_mul_f32 v174, v2, v174
    v_mul_f32 v175, v2, v175
    v_cvt_pk_bf16_f32 v167, v174, v175
    v_mfma_f32_32x32x16_bf16 v[192:207], v[144:147], v[32:35], 0
    s_barrier
    ds_write_b64 v28, v[160:161] offset:0
    ds_write_b64 v28, v[162:163] offset:16
    ds_write_b64 v28, v[164:165] offset:32
    ds_write_b64 v28, v[166:167] offset:48
    ds_read_b32 v8, v7 offset:12288
    ds_read_b128 v[56:59], v6 offset:0
    v_mfma_f32_32x32x16_bf16 v[192:207], v[148:151], v[36:39], v[192:207]
    ds_read_b128 v[60:63], v6 offset:1024
    ds_read_b128 v[64:67], v6 offset:2048
    ds_read_b128 v[68:71], v6 offset:3072
    ds_read_b128 v[72:75], v6 offset:4096
    ds_read_b128 v[76:79], v6 offset:5120
    ds_read_b128 v[80:83], v6 offset:6144
    v_mfma_f32_32x32x16_bf16 v[192:207], v[152:155], v[40:43], v[192:207]
    ds_read_b128 v[84:87], v6 offset:7168
    ds_read_b128 v[88:91], v6 offset:8192
    ds_read_b128 v[92:95], v6 offset:9216
    v_mul_f32 v176, v2, v176
    v_mul_f32 v177, v2, v177
    v_cvt_pk_bf16_f32 v176, v176, v177
    v_mfma_f32_32x32x16_bf16 v[192:207], v[156:159], v[44:47], v[192:207]
    v_mul_f32 v178, v2, v178
    v_mul_f32 v179, v2, v179
    v_cvt_pk_bf16_f32 v177, v178, v179
    v_mul_f32 v180, v2, v180
    v_mul_f32 v181, v2, v181
    v_cvt_pk_bf16_f32 v178, v180, v181
    v_mfma_f32_32x32x16_bf16 v[192:207], a[244:247], v[48:51], v[192:207]
    v_mul_f32 v182, v2, v182
    v_mul_f32 v183, v2, v183
    v_cvt_pk_bf16_f32 v179, v182, v183
    v_mul_f32 v184, v2, v184
    v_mul_f32 v185, v2, v185
    v_cvt_pk_bf16_f32 v180, v184, v185
    v_mfma_f32_32x32x16_bf16 v[192:207], a[248:251], v[52:55], v[192:207]
    v_mul_f32 v186, v2, v186
    v_mul_f32 v187, v2, v187
    v_cvt_pk_bf16_f32 v181, v186, v187
    v_mul_f32 v188, v2, v188
    v_mul_f32 v189, v2, v189
    v_cvt_pk_bf16_f32 v182, v188, v189
    v_mul_f32 v190, v2, v190
    v_mul_f32 v191, v2, v191
    v_cvt_pk_bf16_f32 v183, v190, v191
    ds_write_b64 v28, v[176:177] offset:64
    ds_write_b64 v28, v[178:179] offset:80
    ds_write_b64 v28, v[180:181] offset:96
    ds_write_b64 v28, v[182:183] offset:112
    ds_read_b128 v[32:35], v6 offset:10240
    ds_read_b128 v[36:39], v6 offset:11264
    s_waitcnt lgkmcnt(6)
    v_add_f32 v18, v18, v8
    v_pk_add_f32 v[208:209], v[208:209], v[56:57]
    v_pk_add_f32 v[210:211], v[210:211], v[58:59]
    v_pk_add_f32 v[212:213], v[212:213], v[60:61]
    v_pk_add_f32 v[214:215], v[214:215], v[62:63]
    v_pk_add_f32 v[216:217], v[216:217], v[64:65]
    v_pk_add_f32 v[218:219], v[218:219], v[66:67]
    v_pk_add_f32 v[220:221], v[220:221], v[68:69]
    v_pk_add_f32 v[222:223], v[222:223], v[70:71]
    v_pk_add_f32 v[224:225], v[224:225], v[72:73]
    v_pk_add_f32 v[226:227], v[226:227], v[74:75]
    v_pk_add_f32 v[228:229], v[228:229], v[76:77]
    v_pk_add_f32 v[230:231], v[230:231], v[78:79]
    v_pk_add_f32 v[232:233], v[232:233], v[80:81]
    v_pk_add_f32 v[234:235], v[234:235], v[82:83]
    v_pk_add_f32 v[236:237], v[236:237], v[84:85]
    v_pk_add_f32 v[238:239], v[238:239], v[86:87]
    v_pk_add_f32 v[240:241], v[240:241], v[88:89]
    v_pk_add_f32 v[242:243], v[242:243], v[90:91]
    v_pk_add_f32 v[244:245], v[244:245], v[92:93]
    v_pk_add_f32 v[246:247], v[246:247], v[94:95]
    v_pk_mul_f32 v[192:193], v[192:193], v[2:3]
    v_pk_mul_f32 v[194:195], v[194:195], v[2:3]
    v_pk_mul_f32 v[196:197], v[196:197], v[2:3]
    v_pk_mul_f32 v[198:199], v[198:199], v[2:3]
    v_pk_mul_f32 v[200:201], v[200:201], v[2:3]
    v_pk_mul_f32 v[202:203], v[202:203], v[2:3]
    v_pk_mul_f32 v[204:205], v[204:205], v[2:3]
    v_pk_mul_f32 v[206:207], v[206:207], v[2:3]
    v_cvt_pk_bf16_f32 v192, v192, v193
    v_cvt_pk_bf16_f32 v193, v194, v195
    v_cvt_pk_bf16_f32 v194, v196, v197
    v_cvt_pk_bf16_f32 v195, v198, v199
    v_cvt_pk_bf16_f32 v196, v200, v201
    v_cvt_pk_bf16_f32 v197, v202, v203
    v_cvt_pk_bf16_f32 v198, v204, v205
    v_cvt_pk_bf16_f32 v199, v206, v207
    ds_write_b64 v28, v[192:193] offset:128
    ds_write_b64 v28, v[194:195] offset:144
    ds_write_b64 v28, v[196:197] offset:160
    ds_write_b64 v28, v[198:199] offset:176
    s_waitcnt lgkmcnt(4)
    v_pk_add_f32 v[248:249], v[248:249], v[32:33]
    v_pk_add_f32 v[250:251], v[250:251], v[34:35]
    v_pk_add_f32 v[252:253], v[252:253], v[36:37]
    v_pk_add_f32 v[254:255], v[254:255], v[38:39]
    v_mov_b32 v2, v18
    s_nop 1
    v_permlane32_swap_b32 v18, v2
    s_nop 0
    v_add_f32 v2, v18, v2
    v_med3_f32 v3, v2, s58, v9
    v_cmp_neq_f32 vcc, v3, v2
    s_waitcnt lgkmcnt(0)
    ds_read_b128 v[32:35], v25 offset:0
    ds_read_b128 v[36:39], v26 offset:0
    ds_read_b128 v[40:43], v27 offset:0
    ds_read_b128 v[44:47], v25 offset:3328
    ds_read_b128 v[48:51], v26 offset:3328
    ds_read_b128 v[52:55], v27 offset:3328
    s_add_u32 s60, s37, 4096
    s_cbranch_vccnz L_redo_ob
L_redone_ob:
    v_rcp_f32 v2, v2
    v_cvt_pk_bf16_f32 v64, v208, v209
    v_cvt_pk_bf16_f32 v65, v210, v211
    v_cvt_pk_bf16_f32 v66, v212, v213
    v_cvt_pk_bf16_f32 v67, v214, v215
    v_cvt_pk_bf16_f32 v68, v216, v217
    v_cvt_pk_bf16_f32 v69, v218, v219
    v_cvt_pk_bf16_f32 v70, v220, v221
    v_cvt_pk_bf16_f32 v71, v222, v223
    v_mov_b32 v3, v2
    v_mfma_f32_32x32x16_bf16 v[208:223], v[96:99], v[64:67], 0
    v_cvt_pk_bf16_f32 v72, v224, v225
    v_cvt_pk_bf16_f32 v73, v226, v227
    v_cvt_pk_bf16_f32 v74, v228, v229
    v_cvt_pk_bf16_f32 v75, v230, v231
    v_cvt_pk_bf16_f32 v76, v232, v233
    v_cvt_pk_bf16_f32 v77, v234, v235
    v_mfma_f32_32x32x16_bf16 v[208:223], v[100:103], v[68:71], v[208:223]
    s_waitcnt lgkmcnt(0)
    buffer_store_dwordx4 v[32:35], v16, s[20:23], s37 offen offset:0 nt
    v_cvt_pk_bf16_f32 v78, v236, v237
    v_cvt_pk_bf16_f32 v79, v238, v239
    v_cvt_pk_bf16_f32 v80, v240, v241
    v_cvt_pk_bf16_f32 v81, v242, v243
    v_cvt_pk_bf16_f32 v82, v244, v245
    v_mfma_f32_32x32x16_bf16 v[208:223], v[104:107], v[72:75], v[208:223]
    buffer_store_dwordx4 v[36:39], v16, s[20:23], s37 offen offset:1024 nt
    v_cvt_pk_bf16_f32 v83, v246, v247
    v_cvt_pk_bf16_f32 v84, v248, v249
    v_cvt_pk_bf16_f32 v85, v250, v251
    v_cvt_pk_bf16_f32 v86, v252, v253
    v_cvt_pk_bf16_f32 v87, v254, v255
    v_mfma_f32_32x32x16_bf16 v[208:223], v[108:111], v[76:79], v[208:223]
    buffer_store_dwordx4 v[40:43], v16, s[20:23], s37 offen offset:2048 nt
    v_mfma_f32_32x32x16_bf16 v[208:223], v[112:115], v[80:83], v[208:223]
    buffer_store_dwordx4 v[44:47], v16, s[20:23], s37 offen offset:3072 nt
    v_mfma_f32_32x32x16_bf16 v[208:223], v[116:119], v[84:87], v[208:223]
    buffer_store_dwordx4 v[48:51], v16, s[20:23], s60 offen offset:0 nt
    v_mfma_f32_32x32x16_bf16 v[224:239], v[120:123], v[64:67], 0
    buffer_store_dwordx4 v[52:55], v16, s[20:23], s60 offen offset:1024 nt
    v_mfma_f32_32x32x16_bf16 v[224:239], v[124:127], v[68:71], v[224:239]
    v_mfma_f32_32x32x16_bf16 v[224:239], v[128:131], v[72:75], v[224:239]
    v_mul_f32 v208, v2, v208
    v_mul_f32 v209, v2, v209
    v_cvt_pk_bf16_f32 v208, v208, v209
    v_mul_f32 v210, v2, v210
    v_mul_f32 v211, v2, v211
    v_cvt_pk_bf16_f32 v209, v210, v211
    v_mfma_f32_32x32x16_bf16 v[224:239], v[132:135], v[76:79], v[224:239]
    v_mul_f32 v212, v2, v212
    v_mul_f32 v213, v2, v213
    v_cvt_pk_bf16_f32 v210, v212, v213
    v_mul_f32 v214, v2, v214
    v_mul_f32 v215, v2, v215
    v_cvt_pk_bf16_f32 v211, v214, v215
    v_mfma_f32_32x32x16_bf16 v[224:239], v[136:139], v[80:83], v[224:239]
    v_mul_f32 v216, v2, v216
    v_mul_f32 v217, v2, v217
    v_cvt_pk_bf16_f32 v212, v216, v217
    v_mul_f32 v218, v2, v218
    v_mul_f32 v219, v2, v219
    v_cvt_pk_bf16_f32 v213, v218, v219
    v_mfma_f32_32x32x16_bf16 v[224:239], v[140:143], v[84:87], v[224:239]
    v_mul_f32 v220, v2, v220
    v_mul_f32 v221, v2, v221
    v_cvt_pk_bf16_f32 v214, v220, v221
    v_mul_f32 v222, v2, v222
    v_mul_f32 v223, v2, v223
    v_cvt_pk_bf16_f32 v215, v222, v223
    v_mfma_f32_32x32x16_bf16 v[240:255], v[144:147], v[64:67], 0
    ds_write_b64 v28, v[208:209] offset:0
    ds_write_b64 v28, v[210:211] offset:16
    ds_write_b64 v28, v[212:213] offset:32
    ds_write_b64 v28, v[214:215] offset:48
    v_mfma_f32_32x32x16_bf16 v[240:255], v[148:151], v[68:71], v[240:255]
    v_mfma_f32_32x32x16_bf16 v[240:255], v[152:155], v[72:75], v[240:255]
    v_mul_f32 v224, v2, v224
    v_mul_f32 v225, v2, v225
    v_cvt_pk_bf16_f32 v224, v224, v225
    v_mul_f32 v226, v2, v226
    v_mul_f32 v227, v2, v227
    v_cvt_pk_bf16_f32 v225, v226, v227
    v_mfma_f32_32x32x16_bf16 v[240:255], v[156:159], v[76:79], v[240:255]
    v_mul_f32 v228, v2, v228
    v_mul_f32 v229, v2, v229
    v_cvt_pk_bf16_f32 v226, v228, v229
    v_mul_f32 v230, v2, v230
    v_mul_f32 v231, v2, v231
    v_cvt_pk_bf16_f32 v227, v230, v231
    v_mfma_f32_32x32x16_bf16 v[240:255], a[244:247], v[80:83], v[240:255]
    v_mul_f32 v232, v2, v232
    v_mul_f32 v233, v2, v233
    v_cvt_pk_bf16_f32 v228, v232, v233
    v_mul_f32 v234, v2, v234
    v_mul_f32 v235, v2, v235
    v_cvt_pk_bf16_f32 v229, v234, v235
    v_mfma_f32_32x32x16_bf16 v[240:255], a[248:251], v[84:87], v[240:255]
    v_mul_f32 v236, v2, v236
    v_mul_f32 v237, v2, v237
    v_cvt_pk_bf16_f32 v230, v236, v237
    v_mul_f32 v238, v2, v238
    v_mul_f32 v239, v2, v239
    v_cvt_pk_bf16_f32 v231, v238, v239
    ds_write_b64 v28, v[224:225] offset:64
    ds_write_b64 v28, v[226:227] offset:80
    ds_write_b64 v28, v[228:229] offset:96
    ds_write_b64 v28, v[230:231] offset:112
    s_nop 3
    v_pk_mul_f32 v[240:241], v[240:241], v[2:3]
    v_pk_mul_f32 v[242:243], v[242:243], v[2:3]
    v_pk_mul_f32 v[244:245], v[244:245], v[2:3]
    v_pk_mul_f32 v[246:247], v[246:247], v[2:3]
    v_pk_mul_f32 v[248:249], v[248:249], v[2:3]
    v_pk_mul_f32 v[250:251], v[250:251], v[2:3]
    v_pk_mul_f32 v[252:253], v[252:253], v[2:3]
    v_pk_mul_f32 v[254:255], v[254:255], v[2:3]
    v_cvt_pk_bf16_f32 v240, v240, v241
    v_cvt_pk_bf16_f32 v241, v242, v243
    v_cvt_pk_bf16_f32 v242, v244, v245
    v_cvt_pk_bf16_f32 v243, v246, v247
    v_cvt_pk_bf16_f32 v244, v248, v249
    v_cvt_pk_bf16_f32 v245, v250, v251
    v_cvt_pk_bf16_f32 v246, v252, v253
    v_cvt_pk_bf16_f32 v247, v254, v255
    ds_write_b64 v28, v[240:241] offset:128
    ds_write_b64 v28, v[242:243] offset:144
    ds_write_b64 v28, v[244:245] offset:160
    ds_write_b64 v28, v[246:247] offset:176
    s_waitcnt lgkmcnt(0)
    ds_read_b128 v[64:67], v25 offset:0
    ds_read_b128 v[68:71], v26 offset:0
    ds_read_b128 v[72:75], v27 offset:0
    ds_read_b128 v[76:79], v25 offset:3328
    ds_read_b128 v[80:83], v26 offset:3328
    ds_read_b128 v[84:87], v27 offset:3328
    s_add_u32 s60, s38, 4096
    s_waitcnt lgkmcnt(5)
    buffer_store_dwordx4 v[64:67], v16, s[20:23], s38 offen offset:0 nt
    s_waitcnt lgkmcnt(4)
    buffer_store_dwordx4 v[68:71], v16, s[20:23], s38 offen offset:1024 nt
    s_waitcnt lgkmcnt(3)
    buffer_store_dwordx4 v[72:75], v16, s[20:23], s38 offen offset:2048 nt
    s_waitcnt lgkmcnt(2)
    buffer_store_dwordx4 v[76:79], v16, s[20:23], s38 offen offset:3072 nt
    s_waitcnt lgkmcnt(1)
    buffer_store_dwordx4 v[80:83], v16, s[20:23], s60 offen offset:0 nt
    s_waitcnt lgkmcnt(0)
    buffer_store_dwordx4 v[84:87], v16, s[20:23], s60 offen offset:1024 nt
    s_endpgm
L_slow_h:
L_spin_h:
    buffer_load_dwordx2 v[22:23], v11, s[24:27], s41 offen sc1
    s_waitcnt vmcnt(0)
    v_cmp_ne_u64 vcc, s[4:5], v[22:23]
    s_cbranch_vccz L_spin_h_ok
    s_sleep 4
    s_add_u32 s15, s15, 1
    s_cmp_lt_u32 s15, 0x8000
    s_cbranch_scc1 L_spin_h
L_spin_h_ok:
    s_branch L_back_h
L_slow_o:
L_spin_o:
    buffer_load_dwordx2 v[22:23], v11, s[24:27], s41 offen sc1
    s_waitcnt vmcnt(0)
    v_cmp_ne_u64 vcc, s[4:5], v[22:23]
    s_cbranch_vccz L_spin_o_ok
    s_sleep 4
    s_add_u32 s15, s15, 1
    s_cmp_lt_u32 s15, 0x8000
    s_cbranch_scc1 L_spin_o
L_spin_o_ok:
    s_branch L_back_o
L_sp_vo:
    s_cmp_gt_u32 s2, 8
    s_cbranch_scc1 L_end
    s_mov_b32 s20, s10
    s_mov_b32 s21, s11
    s_mov_b32 s22, 18432
    s_mov_b32 s23, 0x20000
    v_lshlrev_b32 v7, 4, v1
    v_lshrrev_b32 v56, 2, v1
    v_and_b32 v57, 3, v1
    v_mul_u32_u24 v56, 192, v56
    v_lshl_add_u32 v56, v57, 4, v56
    s_lshl_b32 s31, s30, 6
    s_mov_b32 s34, 0

    s_mov_b32 m0, s34
    s_add_u32 s34, s34, 1024
    buffer_load_dwordx4 v56, s[20:23], s31 offen lds
    s_add_u32 s31, s31, 3072
    s_mov_b32 m0, s34
    s_add_u32 s34, s34, 1024
    buffer_load_dwordx4 v56, s[20:23], s31 offen lds
    s_add_u32 s31, s31, 3072
    s_mov_b32 m0, s34
    s_add_u32 s34, s34, 1024
    buffer_load_dwordx4 v56, s[20:23], s31 offen lds
    s_add_u32 s31, s31, 3072
    s_mov_b32 m0, s34
    s_add_u32 s34, s34, 1024
    buffer_load_dwordx4 v56, s[20:23], s31 offen lds
    s_add_u32 s31, s31, 3072
    s_mov_b32 m0, s34
    s_add_u32 s34, s34, 1024
    buffer_load_dwordx4 v56, s[20:23], s31 offen lds
    s_add_u32 s31, s31, 3072
    s_mov_b32 m0, s34
    s_add_u32 s34, s34, 1024
    buffer_load_dwordx4 v56, s[20:23], s31 offen lds
    s_add_u32 s31, s31, 3072
    s_mul_i32 s32, s29, 12288
    buffer_load_dwordx4 v[8:11], v6, s[56:59], s32 offen offset:192
    buffer_load_dwordx4 v[12:15], v6, s[56:59], s32 offen offset:224
    buffer_load_dwordx4 v[16:19], v6, s[56:59], s32 offen offset:256
    buffer_load_dwordx4 v[20:23], v6, s[56:59], s32 offen offset:288
    buffer_load_dwordx4 v[24:27], v6, s[56:59], s32 offen offset:320
    buffer_load_dwordx4 v[28:31], v6, s[56:59], s32 offen offset:352
    v_bfe_u32 v56, v1, 2, 2
    v_lshl_add_u32 v56, v4, 3, v56
    v_lshlrev_b32 v56, 6, v56
    v_bfe_u32 v58, v1, 4, 1
    v_lshl_add_u32 v56, v58, 5, v56
    v_lshl_add_u32 v56, v57, 3, v56
    s_mul_i32 s33, s30, 6528
    s_mul_i32 s34, s29, 2176
    s_add_u32 s33, s33, s34
    s_add_u32 s33, s33, 163200
    s_lshl_b32 s36, s30, 3
    s_add_u32 s36, s36, s29
    s_add_u32 s36, s36, 200
    s_lshl_b32 s36, s36, 4
    s_add_u32 s36, s36, 201216
    s_waitcnt vmcnt(6)

    ds_read_b64_tr_b16 v[32:33], v56 offset:0
    ds_read_b64_tr_b16 v[34:35], v56 offset:256
    ds_read_b64_tr_b16 v[36:37], v56 offset:1024
    ds_read_b64_tr_b16 v[38:39], v56 offset:1280
    ds_read_b64_tr_b16 v[40:41], v56 offset:2048
    ds_read_b64_tr_b16 v[42:43], v56 offset:2304
    ds_read_b64_tr_b16 v[44:45], v56 offset:3072
    ds_read_b64_tr_b16 v[46:47], v56 offset:3328
    ds_read_b64_tr_b16 v[48:49], v56 offset:4096
    ds_read_b64_tr_b16 v[50:51], v56 offset:4352
    ds_read_b64_tr_b16 v[52:53], v56 offset:5120
    ds_read_b64_tr_b16 v[54:55], v56 offset:5376
    s_waitcnt vmcnt(0) lgkmcnt(0)
    v_mfma_f32_32x32x16_bf16 v[64:79], v[8:11], v[32:35], 0
    v_mfma_f32_32x32x16_bf16 v[64:79], v[12:15], v[36:39], v[64:79]
    v_mfma_f32_32x32x16_bf16 v[64:79], v[16:19], v[40:43], v[64:79]
    v_mfma_f32_32x32x16_bf16 v[64:79], v[20:23], v[44:47], v[64:79]
    v_mfma_f32_32x32x16_bf16 v[64:79], v[24:27], v[48:51], v[64:79]
    v_mfma_f32_32x32x16_bf16 v[64:79], v[28:31], v[52:55], v[64:79]
    s_nop 15
    v_cvt_pk_bf16_f32 v80, v64, v65
    v_cvt_pk_bf16_f32 v81, v66, v67
    v_cvt_pk_bf16_f32 v82, v68, v69
    v_cvt_pk_bf16_f32 v83, v70, v71
    v_cvt_pk_bf16_f32 v84, v72, v73
    v_cvt_pk_bf16_f32 v85, v74, v75
    v_cvt_pk_bf16_f32 v86, v76, v77
    v_cvt_pk_bf16_f32 v87, v78, v79
    buffer_store_dwordx4 v[80:83], v7, s[24:27], s33 offen offset:0 sc1
    buffer_store_dwordx4 v[84:87], v7, s[24:27], s33 offen offset:1088 sc1
    s_branch L_sp_flag
L_redo_h:
    s_waitcnt vmcnt(0) lgkmcnt(0)
    v_lshrrev_b32 v4, 5, v1
    v_mul_u32_u24 v12, 1088, v4
    v_and_b32 v5, 31, v1
    v_lshl_add_u32 v12, v5, 4, v12
    v_bfe_u32 v5, v1, 2, 2
    v_lshl_add_u32 v5, v4, 2, v5
    v_lshlrev_b32 v14, 4, v5
    v_bfe_u32 v5, v1, 1, 1
    v_lshl_add_u32 v14, v5, 3, v14
    v_and_b32 v5, 1, v1
    v_mul_u32_u24 v5, 1088, v5
    v_add_u32 v14, v14, v5
    v_bfe_u32 v5, v1, 4, 1
    v_mul_u32_u24 v4, 2176, v5
    v_add_u32 v13, v14, v4
    v_lshl_add_u32 v14, v5, 9, v14

    s_mul_i32 s59, s14, 6656
    s_add_u32 s59, s59, 115968
    v_add_u32 v12, s59, v12
    v_add_u32 v13, s59, v13
    v_add_u32 v14, s59, v14
    v_mov_b32 v4, 0xff800000
    s_mov_b32 s55, 0
L_redo1_h:
    s_mov_b32 m0, s59
    s_add_u32 s57, s55, 4352
    buffer_load_dwordx4 v16, s[24:27], s55 offen offset:0 sc1 lds
    buffer_load_dwordx4 v16, s[24:27], s55 offen offset:1088 sc1 lds
    buffer_load_dwordx4 v16, s[24:27], s55 offen offset:2176 sc1 lds
    buffer_load_dwordx4 v16, s[24:27], s55 offen offset:3264 sc1 lds
    s_add_u32 m0, s59, 4352
    s_nop 0
    buffer_load_dwordx4 v16, s[24:27], s57 offen offset:0 sc1 lds
    buffer_load_dwordx4 v16, s[24:27], s57 offen offset:1088 sc1 lds
    s_waitcnt vmcnt(0)
    ds_read_b128 a[192:195], v12 offset:0
    ds_read_b128 a[196:199], v12 offset:2176
    ds_read_b128 a[200:203], v12 offset:512
    ds_read_b128 a[204:207], v12 offset:2688
    ds_read_b128 a[208:211], v12 offset:4352
    ds_read_b128 a[212:215], v12 offset:4864
    s_waitcnt lgkmcnt(0)
    v_mfma_f32_32x32x16_bf16 v[64:79], a[192:195], a[96:99], 0
    v_mfma_f32_32x32x16_bf16 v[64:79], a[196:199], a[100:103], v[64:79]
    v_mfma_f32_32x32x16_bf16 v[64:79], a[200:203], a[104:107], v[64:79]
    v_mfma_f32_32x32x16_bf16 v[64:79], a[204:207], a[108:111], v[64:79]
    v_mfma_f32_32x32x16_bf16 v[64:79], a[208:211], a[112:115], v[64:79]
    v_mfma_f32_32x32x16_bf16 v[64:79], a[212:215], a[116:119], v[64:79]
    s_nop 15
    s_cmp_eq_u32 s55, 156672
    s_cbranch_scc1 L_redo1e_h
    v_max3_f32 v4, v4, v64, v65
    v_max3_f32 v4, v4, v66, v67
    v_max3_f32 v4, v4, v68, v69
    v_max3_f32 v4, v4, v70, v71
    v_max3_f32 v4, v4, v72, v73
    v_max3_f32 v4, v4, v74, v75
    v_max3_f32 v4, v4, v76, v77
    v_max3_f32 v4, v4, v78, v79
    s_add_u32 s55, s55, 6528
    s_branch L_redo1_h
L_redo1e_h:
    v_max3_f32 v4, v4, v64, v65
    v_max3_f32 v4, v4, v66, v67
    v_max3_f32 v4, v4, v68, v69
    v_max3_f32 v4, v4, v70, v71
    v_mov_b32 v5, v4
    s_nop 1
    v_permlane32_swap_b32 v4, v5
    s_nop 0
    v_max_f32 v4, v4, v5
    v_sub_f32 v80, 0, v4
    v_sub_f32 v81, 0, v4
    v_sub_f32 v82, 0, v4
    v_sub_f32 v83, 0, v4
    v_sub_f32 v84, 0, v4
    v_sub_f32 v85, 0, v4
    v_sub_f32 v86, 0, v4
    v_sub_f32 v87, 0, v4
    v_sub_f32 v88, 0, v4
    v_sub_f32 v89, 0, v4
    v_sub_f32 v90, 0, v4
    v_sub_f32 v91, 0, v4
    v_sub_f32 v92, 0, v4
    v_sub_f32 v93, 0, v4
    v_sub_f32 v94, 0, v4
    v_sub_f32 v95, 0, v4
    v_mov_b32 v160, 0
    v_mov_b32 v161, 0
    v_mov_b32 v162, 0
    v_mov_b32 v163, 0
    v_mov_b32 v164, 0
    v_mov_b32 v165, 0
    v_mov_b32 v166, 0
    v_mov_b32 v167, 0
    v_mov_b32 v168, 0
    v_mov_b32 v169, 0
    v_mov_b32 v170, 0
    v_mov_b32 v171, 0
    v_mov_b32 v172, 0
    v_mov_b32 v173, 0
    v_mov_b32 v174, 0
    v_mov_b32 v175, 0
    v_mov_b32 v176, 0
    v_mov_b32 v177, 0
    v_mov_b32 v178, 0
    v_mov_b32 v179, 0
    v_mov_b32 v180, 0
    v_mov_b32 v181, 0
    v_mov_b32 v182, 0
    v_mov_b32 v183, 0
    v_mov_b32 v184, 0
    v_mov_b32 v185, 0
    v_mov_b32 v186, 0
    v_mov_b32 v187, 0
    v_mov_b32 v188, 0
    v_mov_b32 v189, 0
    v_mov_b32 v190, 0
    v_mov_b32 v191, 0
    v_mov_b32 v192, 0
    v_mov_b32 v193, 0
    v_mov_b32 v194, 0
    v_mov_b32 v195, 0
    v_mov_b32 v196, 0
    v_mov_b32 v197, 0
    v_mov_b32 v198, 0
    v_mov_b32 v199, 0
    v_mov_b32 v200, 0
    v_mov_b32 v201, 0
    v_mov_b32 v202, 0
    v_mov_b32 v203, 0
    v_mov_b32 v204, 0
    v_mov_b32 v205, 0
    v_mov_b32 v206, 0
    v_mov_b32 v207, 0
    v_mov_b32 v17, 0
    s_mov_b32 s55, 0
L_redo2_h:
    s_mov_b32 m0, s59
    s_add_u32 s57, s55, 4352
    buffer_load_dwordx4 v16, s[24:27], s55 offen offset:0 sc1 lds
    buffer_load_dwordx4 v16, s[24:27], s55 offen offset:1088 sc1 lds
    buffer_load_dwordx4 v16, s[24:27], s55 offen offset:2176 sc1 lds
    buffer_load_dwordx4 v16, s[24:27], s55 offen offset:3264 sc1 lds
    s_add_u32 m0, s59, 4352
    s_nop 0
    buffer_load_dwordx4 v16, s[24:27], s57 offen offset:0 sc1 lds
    buffer_load_dwordx4 v16, s[24:27], s57 offen offset:1088 sc1 lds
    s_waitcnt vmcnt(0)
    ds_read_b128 a[192:195], v12 offset:0
    ds_read_b128 a[196:199], v12 offset:2176
    ds_read_b128 a[200:203], v12 offset:512
    ds_read_b128 a[204:207], v12 offset:2688
    ds_read_b128 a[208:211], v12 offset:4352
    ds_read_b128 a[212:215], v12 offset:4864
    ds_read_b64_tr_b16 a[216:217], v13 offset:0
    ds_read_b64_tr_b16 a[218:219], v13 offset:128
    ds_read_b64_tr_b16 a[220:221], v13 offset:512
    ds_read_b64_tr_b16 a[222:223], v13 offset:640
    ds_read_b64_tr_b16 a[224:225], v14 offset:4352
    ds_read_b64_tr_b16 a[226:227], v14 offset:4480
    ds_read_b64_tr_b16 a[228:229], v13 offset:256
    ds_read_b64_tr_b16 a[230:231], v13 offset:384
    ds_read_b64_tr_b16 a[232:233], v13 offset:768
    ds_read_b64_tr_b16 a[234:235], v13 offset:896
    ds_read_b64_tr_b16 a[236:237], v14 offset:4608
    ds_read_b64_tr_b16 a[238:239], v14 offset:4736
    s_waitcnt lgkmcnt(0)
    v_mfma_f32_32x32x16_bf16 v[64:79], a[192:195], a[96:99], v[80:95]
    v_mfma_f32_32x32x16_bf16 v[64:79], a[196:199], a[100:103], v[64:79]
    v_mfma_f32_32x32x16_bf16 v[64:79], a[200:203], a[104:107], v[64:79]
    v_mfma_f32_32x32x16_bf16 v[64:79], a[204:207], a[108:111], v[64:79]
    v_mfma_f32_32x32x16_bf16 v[64:79], a[208:211], a[112:115], v[64:79]
    v_mfma_f32_32x32x16_bf16 v[64:79], a[212:215], a[116:119], v[64:79]
    s_nop 15
    s_cmp_eq_u32 s55, 156672
    s_cbranch_scc1 L_redo2e_h
    v_exp_f32 v64, v64
    v_exp_f32 v65, v65
    v_exp_f32 v66, v66
    v_exp_f32 v67, v67
    v_exp_f32 v68, v68
    v_exp_f32 v69, v69
    v_exp_f32 v70, v70
    v_exp_f32 v71, v71
    v_exp_f32 v72, v72
    v_exp_f32 v73, v73
    v_exp_f32 v74, v74
    v_exp_f32 v75, v75
    v_exp_f32 v76, v76
    v_exp_f32 v77, v77
    v_exp_f32 v78, v78
    v_exp_f32 v79, v79
    s_nop 0
    v_add_f32 v17, v17, v64
    v_add_f32 v17, v17, v65
    v_add_f32 v17, v17, v66
    v_add_f32 v17, v17, v67
    v_add_f32 v17, v17, v68
    v_add_f32 v17, v17, v69
    v_add_f32 v17, v17, v70
    v_add_f32 v17, v17, v71
    v_add_f32 v17, v17, v72
    v_add_f32 v17, v17, v73
    v_add_f32 v17, v17, v74
    v_add_f32 v17, v17, v75
    v_add_f32 v17, v17, v76
    v_add_f32 v17, v17, v77
    v_add_f32 v17, v17, v78
    v_add_f32 v17, v17, v79
    v_cvt_pk_bf16_f32 v64, v64, v65
    v_cvt_pk_bf16_f32 v65, v66, v67
    v_cvt_pk_bf16_f32 v66, v68, v69
    v_cvt_pk_bf16_f32 v67, v70, v71
    v_cvt_pk_bf16_f32 v72, v72, v73
    v_cvt_pk_bf16_f32 v73, v74, v75
    v_cvt_pk_bf16_f32 v74, v76, v77
    v_cvt_pk_bf16_f32 v75, v78, v79
    s_nop 1
    v_mfma_f32_32x32x16_bf16 v[160:175], a[216:219], v[64:67], v[160:175]
    v_mfma_f32_32x32x16_bf16 v[176:191], a[220:223], v[64:67], v[176:191]
    v_mfma_f32_32x32x16_bf16 v[192:207], a[224:227], v[64:67], v[192:207]
    v_mfma_f32_32x32x16_bf16 v[160:175], a[228:231], v[72:75], v[160:175]
    v_mfma_f32_32x32x16_bf16 v[176:191], a[232:235], v[72:75], v[176:191]
    v_mfma_f32_32x32x16_bf16 v[192:207], a[236:239], v[72:75], v[192:207]
    s_add_u32 s55, s55, 6528
    s_branch L_redo2_h
L_redo2e_h:
    v_exp_f32 v64, v64
    v_exp_f32 v65, v65
    v_exp_f32 v66, v66
    v_exp_f32 v67, v67
    v_exp_f32 v68, v68
    v_exp_f32 v69, v69
    v_exp_f32 v70, v70
    v_exp_f32 v71, v71
    s_nop 0
    v_add_f32 v17, v17, v64
    v_add_f32 v17, v17, v65
    v_add_f32 v17, v17, v66
    v_add_f32 v17, v17, v67
    v_add_f32 v17, v17, v68
    v_add_f32 v17, v17, v69
    v_add_f32 v17, v17, v70
    v_add_f32 v17, v17, v71
    v_cvt_pk_bf16_f32 v64, v64, v65
    v_cvt_pk_bf16_f32 v65, v66, v67
    v_cvt_pk_bf16_f32 v66, v68, v69
    v_cvt_pk_bf16_f32 v67, v70, v71
    s_nop 1
    v_mfma_f32_32x32x16_bf16 v[160:175], a[216:219], v[64:67], v[160:175]
    v_mfma_f32_32x32x16_bf16 v[176:191], a[220:223], v[64:67], v[176:191]
    v_mfma_f32_32x32x16_bf16 v[192:207], a[224:227], v[64:67], v[192:207]
    v_mov_b32 v2, v17
    s_nop 1
    v_permlane32_swap_b32 v17, v2
    s_nop 0
    v_add_f32 v2, v17, v2
    s_nop 15
    s_branch L_redone_h
L_redo_oo:
    s_waitcnt vmcnt(0) lgkmcnt(0)
    v_lshrrev_b32 v4, 5, v1
    v_mul_u32_u24 v12, 1088, v4
    v_and_b32 v5, 31, v1
    v_lshl_add_u32 v12, v5, 4, v12
    v_bfe_u32 v5, v1, 2, 2
    v_lshl_add_u32 v5, v4, 2, v5
    v_lshlrev_b32 v14, 4, v5
    v_bfe_u32 v5, v1, 1, 1
    v_lshl_add_u32 v14, v5, 3, v14
    v_and_b32 v5, 1, v1
    v_mul_u32_u24 v5, 1088, v5
    v_add_u32 v14, v14, v5
    v_bfe_u32 v5, v1, 4, 1
    v_mul_u32_u24 v4, 2176, v5
    v_add_u32 v13, v14, v4
    v_lshl_add_u32 v14, v5, 9, v14

    s_mul_i32 s59, s14, 6656
    s_add_u32 s59, s59, 115968
    v_add_u32 v12, s59, v12
    v_add_u32 v13, s59, v13
    v_add_u32 v14, s59, v14
    v_mov_b32 v4, 0xff800000
    s_mov_b32 s55, 0
L_redo1_oo:
    s_mov_b32 m0, s59
    s_add_u32 s57, s55, 4352
    buffer_load_dwordx4 v16, s[24:27], s55 offen offset:0 sc1 lds
    buffer_load_dwordx4 v16, s[24:27], s55 offen offset:1088 sc1 lds
    buffer_load_dwordx4 v16, s[24:27], s55 offen offset:2176 sc1 lds
    buffer_load_dwordx4 v16, s[24:27], s55 offen offset:3264 sc1 lds
    s_add_u32 m0, s59, 4352
    s_nop 0
    buffer_load_dwordx4 v16, s[24:27], s57 offen offset:0 sc1 lds
    buffer_load_dwordx4 v16, s[24:27], s57 offen offset:1088 sc1 lds
    s_waitcnt vmcnt(0)
    ds_read_b128 a[192:195], v12 offset:0
    ds_read_b128 a[196:199], v12 offset:2176
    ds_read_b128 a[200:203], v12 offset:512
    ds_read_b128 a[204:207], v12 offset:2688
    ds_read_b128 a[208:211], v12 offset:4352
    ds_read_b128 a[212:215], v12 offset:4864
    s_waitcnt lgkmcnt(0)
    v_mfma_f32_32x32x16_bf16 v[64:79], a[192:195], a[96:99], 0
    v_mfma_f32_32x32x16_bf16 v[64:79], a[196:199], a[100:103], v[64:79]
    v_mfma_f32_32x32x16_bf16 v[64:79], a[200:203], a[104:107], v[64:79]
    v_mfma_f32_32x32x16_bf16 v[64:79], a[204:207], a[108:111], v[64:79]
    v_mfma_f32_32x32x16_bf16 v[64:79], a[208:211], a[112:115], v[64:79]
    v_mfma_f32_32x32x16_bf16 v[64:79], a[212:215], a[116:119], v[64:79]
    s_nop 15
    s_cmp_eq_u32 s55, 156672
    s_cbranch_scc1 L_redo1e_oo
    v_max3_f32 v4, v4, v64, v65
    v_max3_f32 v4, v4, v66, v67
    v_max3_f32 v4, v4, v68, v69
    v_max3_f32 v4, v4, v70, v71
    v_max3_f32 v4, v4, v72, v73
    v_max3_f32 v4, v4, v74, v75
    v_max3_f32 v4, v4, v76, v77
    v_max3_f32 v4, v4, v78, v79
    s_add_u32 s55, s55, 6528
    s_branch L_redo1_oo
L_redo1e_oo:
    v_max3_f32 v4, v4, v64, v65
    v_max3_f32 v4, v4, v66, v67
    v_max3_f32 v4, v4, v68, v69
    v_max3_f32 v4, v4, v70, v71
    v_mov_b32 v5, v4
    s_nop 1
    v_permlane32_swap_b32 v4, v5
    s_nop 0
    v_max_f32 v4, v4, v5
    v_sub_f32 v80, 0, v4
    v_sub_f32 v81, 0, v4
    v_sub_f32 v82, 0, v4
    v_sub_f32 v83, 0, v4
    v_sub_f32 v84, 0, v4
    v_sub_f32 v85, 0, v4
    v_sub_f32 v86, 0, v4
    v_sub_f32 v87, 0, v4
    v_sub_f32 v88, 0, v4
    v_sub_f32 v89, 0, v4
    v_sub_f32 v90, 0, v4
    v_sub_f32 v91, 0, v4
    v_sub_f32 v92, 0, v4
    v_sub_f32 v93, 0, v4
    v_sub_f32 v94, 0, v4
    v_sub_f32 v95, 0, v4
    v_mov_b32 v160, 0
    v_mov_b32 v161, 0
    v_mov_b32 v162, 0
    v_mov_b32 v163, 0
    v_mov_b32 v164, 0
    v_mov_b32 v165, 0
    v_mov_b32 v166, 0
    v_mov_b32 v167, 0
    v_mov_b32 v168, 0
    v_mov_b32 v169, 0
    v_mov_b32 v170, 0
    v_mov_b32 v171, 0
    v_mov_b32 v172, 0
    v_mov_b32 v173, 0
    v_mov_b32 v174, 0
    v_mov_b32 v175, 0
    v_mov_b32 v176, 0
    v_mov_b32 v177, 0
    v_mov_b32 v178, 0
    v_mov_b32 v179, 0
    v_mov_b32 v180, 0
    v_mov_b32 v181, 0
    v_mov_b32 v182, 0
    v_mov_b32 v183, 0
    v_mov_b32 v184, 0
    v_mov_b32 v185, 0
    v_mov_b32 v186, 0
    v_mov_b32 v187, 0
    v_mov_b32 v188, 0
    v_mov_b32 v189, 0
    v_mov_b32 v190, 0
    v_mov_b32 v191, 0
    v_mov_b32 v192, 0
    v_mov_b32 v193, 0
    v_mov_b32 v194, 0
    v_mov_b32 v195, 0
    v_mov_b32 v196, 0
    v_mov_b32 v197, 0
    v_mov_b32 v198, 0
    v_mov_b32 v199, 0
    v_mov_b32 v200, 0
    v_mov_b32 v201, 0
    v_mov_b32 v202, 0
    v_mov_b32 v203, 0
    v_mov_b32 v204, 0
    v_mov_b32 v205, 0
    v_mov_b32 v206, 0
    v_mov_b32 v207, 0
    v_mov_b32 v17, 0
    s_mov_b32 s55, 0
L_redo2_oo:
    s_mov_b32 m0, s59
    s_add_u32 s57, s55, 4352
    buffer_load_dwordx4 v16, s[24:27], s55 offen offset:0 sc1 lds
    buffer_load_dwordx4 v16, s[24:27], s55 offen offset:1088 sc1 lds
    buffer_load_dwordx4 v16, s[24:27], s55 offen offset:2176 sc1 lds
    buffer_load_dwordx4 v16, s[24:27], s55 offen offset:3264 sc1 lds
    s_add_u32 m0, s59, 4352
    s_nop 0
    buffer_load_dwordx4 v16, s[24:27], s57 offen offset:0 sc1 lds
    buffer_load_dwordx4 v16, s[24:27], s57 offen offset:1088 sc1 lds
    s_waitcnt vmcnt(0)
    ds_read_b128 a[192:195], v12 offset:0
    ds_read_b128 a[196:199], v12 offset:2176
    ds_read_b128 a[200:203], v12 offset:512
    ds_read_b128 a[204:207], v12 offset:2688
    ds_read_b128 a[208:211], v12 offset:4352
    ds_read_b128 a[212:215], v12 offset:4864
    ds_read_b64_tr_b16 a[216:217], v13 offset:0
    ds_read_b64_tr_b16 a[218:219], v13 offset:128
    ds_read_b64_tr_b16 a[220:221], v13 offset:512
    ds_read_b64_tr_b16 a[222:223], v13 offset:640
    ds_read_b64_tr_b16 a[224:225], v14 offset:4352
    ds_read_b64_tr_b16 a[226:227], v14 offset:4480
    ds_read_b64_tr_b16 a[228:229], v13 offset:256
    ds_read_b64_tr_b16 a[230:231], v13 offset:384
    ds_read_b64_tr_b16 a[232:233], v13 offset:768
    ds_read_b64_tr_b16 a[234:235], v13 offset:896
    ds_read_b64_tr_b16 a[236:237], v14 offset:4608
    ds_read_b64_tr_b16 a[238:239], v14 offset:4736
    s_waitcnt lgkmcnt(0)
    v_mfma_f32_32x32x16_bf16 v[64:79], a[192:195], a[96:99], v[80:95]
    v_mfma_f32_32x32x16_bf16 v[64:79], a[196:199], a[100:103], v[64:79]
    v_mfma_f32_32x32x16_bf16 v[64:79], a[200:203], a[104:107], v[64:79]
    v_mfma_f32_32x32x16_bf16 v[64:79], a[204:207], a[108:111], v[64:79]
    v_mfma_f32_32x32x16_bf16 v[64:79], a[208:211], a[112:115], v[64:79]
    v_mfma_f32_32x32x16_bf16 v[64:79], a[212:215], a[116:119], v[64:79]
    s_nop 15
    s_cmp_eq_u32 s55, 156672
    s_cbranch_scc1 L_redo2e_oo
    v_exp_f32 v64, v64
    v_exp_f32 v65, v65
    v_exp_f32 v66, v66
    v_exp_f32 v67, v67
    v_exp_f32 v68, v68
    v_exp_f32 v69, v69
    v_exp_f32 v70, v70
    v_exp_f32 v71, v71
    v_exp_f32 v72, v72
    v_exp_f32 v73, v73
    v_exp_f32 v74, v74
    v_exp_f32 v75, v75
    v_exp_f32 v76, v76
    v_exp_f32 v77, v77
    v_exp_f32 v78, v78
    v_exp_f32 v79, v79
    s_nop 0
    v_add_f32 v17, v17, v64
    v_add_f32 v17, v17, v65
    v_add_f32 v17, v17, v66
    v_add_f32 v17, v17, v67
    v_add_f32 v17, v17, v68
    v_add_f32 v17, v17, v69
    v_add_f32 v17, v17, v70
    v_add_f32 v17, v17, v71
    v_add_f32 v17, v17, v72
    v_add_f32 v17, v17, v73
    v_add_f32 v17, v17, v74
    v_add_f32 v17, v17, v75
    v_add_f32 v17, v17, v76
    v_add_f32 v17, v17, v77
    v_add_f32 v17, v17, v78
    v_add_f32 v17, v17, v79
    v_cvt_pk_bf16_f32 v64, v64, v65
    v_cvt_pk_bf16_f32 v65, v66, v67
    v_cvt_pk_bf16_f32 v66, v68, v69
    v_cvt_pk_bf16_f32 v67, v70, v71
    v_cvt_pk_bf16_f32 v72, v72, v73
    v_cvt_pk_bf16_f32 v73, v74, v75
    v_cvt_pk_bf16_f32 v74, v76, v77
    v_cvt_pk_bf16_f32 v75, v78, v79
    s_nop 1
    v_mfma_f32_32x32x16_bf16 v[160:175], a[216:219], v[64:67], v[160:175]
    v_mfma_f32_32x32x16_bf16 v[176:191], a[220:223], v[64:67], v[176:191]
    v_mfma_f32_32x32x16_bf16 v[192:207], a[224:227], v[64:67], v[192:207]
    v_mfma_f32_32x32x16_bf16 v[160:175], a[228:231], v[72:75], v[160:175]
    v_mfma_f32_32x32x16_bf16 v[176:191], a[232:235], v[72:75], v[176:191]
    v_mfma_f32_32x32x16_bf16 v[192:207], a[236:239], v[72:75], v[192:207]
    s_add_u32 s55, s55, 6528
    s_branch L_redo2_oo
L_redo2e_oo:
    v_exp_f32 v64, v64
    v_exp_f32 v65, v65
    v_exp_f32 v66, v66
    v_exp_f32 v67, v67
    v_exp_f32 v68, v68
    v_exp_f32 v69, v69
    v_exp_f32 v70, v70
    v_exp_f32 v71, v71
    s_nop 0
    v_add_f32 v17, v17, v64
    v_add_f32 v17, v17, v65
    v_add_f32 v17, v17, v66
    v_add_f32 v17, v17, v67
    v_add_f32 v17, v17, v68
    v_add_f32 v17, v17, v69
    v_add_f32 v17, v17, v70
    v_add_f32 v17, v17, v71
    v_cvt_pk_bf16_f32 v64, v64, v65
    v_cvt_pk_bf16_f32 v65, v66, v67
    v_cvt_pk_bf16_f32 v66, v68, v69
    v_cvt_pk_bf16_f32 v67, v70, v71
    s_nop 1
    v_mfma_f32_32x32x16_bf16 v[160:175], a[216:219], v[64:67], v[160:175]
    v_mfma_f32_32x32x16_bf16 v[176:191], a[220:223], v[64:67], v[176:191]
    v_mfma_f32_32x32x16_bf16 v[192:207], a[224:227], v[64:67], v[192:207]
    v_mov_b32 v2, v17
    s_nop 1
    v_permlane32_swap_b32 v17, v2
    s_nop 0
    v_add_f32 v2, v17, v2
    s_nop 15
    s_branch L_redone_oo
L_redo_ob:
    s_waitcnt vmcnt(0) lgkmcnt(0)
    v_lshrrev_b32 v4, 5, v1
    v_mul_u32_u24 v12, 1088, v4
    v_and_b32 v5, 31, v1
    v_lshl_add_u32 v12, v5, 4, v12
    v_bfe_u32 v5, v1, 2, 2
    v_lshl_add_u32 v5, v4, 2, v5
    v_lshlrev_b32 v14, 4, v5
    v_bfe_u32 v5, v1, 1, 1
    v_lshl_add_u32 v14, v5, 3, v14
    v_and_b32 v5, 1, v1
    v_mul_u32_u24 v5, 1088, v5
    v_add_u32 v14, v14, v5
    v_bfe_u32 v5, v1, 4, 1
    v_mul_u32_u24 v4, 2176, v5
    v_add_u32 v13, v14, v4
    v_lshl_add_u32 v14, v5, 9, v14

    s_mul_i32 s59, s14, 6656
    s_add_u32 s59, s59, 115968
    v_add_u32 v12, s59, v12
    v_add_u32 v13, s59, v13
    v_add_u32 v14, s59, v14
    v_mov_b32 v4, 0xff800000
    s_mov_b32 s55, 0
L_redo1_ob:
    s_mov_b32 m0, s59
    s_add_u32 s57, s55, 4352
    buffer_load_dwordx4 v16, s[24:27], s55 offen offset:0 sc1 lds
    buffer_load_dwordx4 v16, s[24:27], s55 offen offset:1088 sc1 lds
    buffer_load_dwordx4 v16, s[24:27], s55 offen offset:2176 sc1 lds
    buffer_load_dwordx4 v16, s[24:27], s55 offen offset:3264 sc1 lds
    s_add_u32 m0, s59, 4352
    s_nop 0
    buffer_load_dwordx4 v16, s[24:27], s57 offen offset:0 sc1 lds
    buffer_load_dwordx4 v16, s[24:27], s57 offen offset:1088 sc1 lds
    s_waitcnt vmcnt(0)
    ds_read_b128 a[192:195], v12 offset:0
    ds_read_b128 a[196:199], v12 offset:2176
    ds_read_b128 a[200:203], v12 offset:512
    ds_read_b128 a[204:207], v12 offset:2688
    ds_read_b128 a[208:211], v12 offset:4352
    ds_read_b128 a[212:215], v12 offset:4864
    s_waitcnt lgkmcnt(0)
    v_mfma_f32_32x32x16_bf16 v[64:79], a[192:195], a[120:123], 0
    v_mfma_f32_32x32x16_bf16 v[64:79], a[196:199], a[124:127], v[64:79]
    v_mfma_f32_32x32x16_bf16 v[64:79], a[200:203], a[128:131], v[64:79]
    v_mfma_f32_32x32x16_bf16 v[64:79], a[204:207], a[132:135], v[64:79]
    v_mfma_f32_32x32x16_bf16 v[64:79], a[208:211], a[136:139], v[64:79]
    v_mfma_f32_32x32x16_bf16 v[64:79], a[212:215], a[140:143], v[64:79]
    s_nop 15
    s_cmp_eq_u32 s55, 156672
    s_cbranch_scc1 L_redo1e_ob
    v_max3_f32 v4, v4, v64, v65
    v_max3_f32 v4, v4, v66, v67
    v_max3_f32 v4, v4, v68, v69
    v_max3_f32 v4, v4, v70, v71
    v_max3_f32 v4, v4, v72, v73
    v_max3_f32 v4, v4, v74, v75
    v_max3_f32 v4, v4, v76, v77
    v_max3_f32 v4, v4, v78, v79
    s_add_u32 s55, s55, 6528
    s_branch L_redo1_ob
L_redo1e_ob:
    v_max3_f32 v4, v4, v64, v65
    v_max3_f32 v4, v4, v66, v67
    v_max3_f32 v4, v4, v68, v69
    v_max3_f32 v4, v4, v70, v71
    v_mov_b32 v5, v4
    s_nop 1
    v_permlane32_swap_b32 v4, v5
    s_nop 0
    v_max_f32 v4, v4, v5
    v_sub_f32 v80, 0, v4
    v_sub_f32 v81, 0, v4
    v_sub_f32 v82, 0, v4
    v_sub_f32 v83, 0, v4
    v_sub_f32 v84, 0, v4
    v_sub_f32 v85, 0, v4
    v_sub_f32 v86, 0, v4
    v_sub_f32 v87, 0, v4
    v_sub_f32 v88, 0, v4
    v_sub_f32 v89, 0, v4
    v_sub_f32 v90, 0, v4
    v_sub_f32 v91, 0, v4
    v_sub_f32 v92, 0, v4
    v_sub_f32 v93, 0, v4
    v_sub_f32 v94, 0, v4
    v_sub_f32 v95, 0, v4
    v_mov_b32 v208, 0
    v_mov_b32 v209, 0
    v_mov_b32 v210, 0
    v_mov_b32 v211, 0
    v_mov_b32 v212, 0
    v_mov_b32 v213, 0
    v_mov_b32 v214, 0
    v_mov_b32 v215, 0
    v_mov_b32 v216, 0
    v_mov_b32 v217, 0
    v_mov_b32 v218, 0
    v_mov_b32 v219, 0
    v_mov_b32 v220, 0
    v_mov_b32 v221, 0
    v_mov_b32 v222, 0
    v_mov_b32 v223, 0
    v_mov_b32 v224, 0
    v_mov_b32 v225, 0
    v_mov_b32 v226, 0
    v_mov_b32 v227, 0
    v_mov_b32 v228, 0
    v_mov_b32 v229, 0
    v_mov_b32 v230, 0
    v_mov_b32 v231, 0
    v_mov_b32 v232, 0
    v_mov_b32 v233, 0
    v_mov_b32 v234, 0
    v_mov_b32 v235, 0
    v_mov_b32 v236, 0
    v_mov_b32 v237, 0
    v_mov_b32 v238, 0
    v_mov_b32 v239, 0
    v_mov_b32 v240, 0
    v_mov_b32 v241, 0
    v_mov_b32 v242, 0
    v_mov_b32 v243, 0
    v_mov_b32 v244, 0
    v_mov_b32 v245, 0
    v_mov_b32 v246, 0
    v_mov_b32 v247, 0
    v_mov_b32 v248, 0
    v_mov_b32 v249, 0
    v_mov_b32 v250, 0
    v_mov_b32 v251, 0
    v_mov_b32 v252, 0
    v_mov_b32 v253, 0
    v_mov_b32 v254, 0
    v_mov_b32 v255, 0
    v_mov_b32 v18, 0
    s_mov_b32 s55, 0
L_redo2_ob:
    s_mov_b32 m0, s59
    s_add_u32 s57, s55, 4352
    buffer_load_dwordx4 v16, s[24:27], s55 offen offset:0 sc1 lds
    buffer_load_dwordx4 v16, s[24:27], s55 offen offset:1088 sc1 lds
    buffer_load_dwordx4 v16, s[24:27], s55 offen offset:2176 sc1 lds
    buffer_load_dwordx4 v16, s[24:27], s55 offen offset:3264 sc1 lds
    s_add_u32 m0, s59, 4352
    s_nop 0
    buffer_load_dwordx4 v16, s[24:27], s57 offen offset:0 sc1 lds
    buffer_load_dwordx4 v16, s[24:27], s57 offen offset:1088 sc1 lds
    s_waitcnt vmcnt(0)
    ds_read_b128 a[192:195], v12 offset:0
    ds_read_b128 a[196:199], v12 offset:2176
    ds_read_b128 a[200:203], v12 offset:512
    ds_read_b128 a[204:207], v12 offset:2688
    ds_read_b128 a[208:211], v12 offset:4352
    ds_read_b128 a[212:215], v12 offset:4864
    ds_read_b64_tr_b16 a[216:217], v13 offset:0
    ds_read_b64_tr_b16 a[218:219], v13 offset:128
    ds_read_b64_tr_b16 a[220:221], v13 offset:512
    ds_read_b64_tr_b16 a[222:223], v13 offset:640
    ds_read_b64_tr_b16 a[224:225], v14 offset:4352
    ds_read_b64_tr_b16 a[226:227], v14 offset:4480
    ds_read_b64_tr_b16 a[228:229], v13 offset:256
    ds_read_b64_tr_b16 a[230:231], v13 offset:384
    ds_read_b64_tr_b16 a[232:233], v13 offset:768
    ds_read_b64_tr_b16 a[234:235], v13 offset:896
    ds_read_b64_tr_b16 a[236:237], v14 offset:4608
    ds_read_b64_tr_b16 a[238:239], v14 offset:4736
    s_waitcnt lgkmcnt(0)
    v_mfma_f32_32x32x16_bf16 v[64:79], a[192:195], a[120:123], v[80:95]
    v_mfma_f32_32x32x16_bf16 v[64:79], a[196:199], a[124:127], v[64:79]
    v_mfma_f32_32x32x16_bf16 v[64:79], a[200:203], a[128:131], v[64:79]
    v_mfma_f32_32x32x16_bf16 v[64:79], a[204:207], a[132:135], v[64:79]
    v_mfma_f32_32x32x16_bf16 v[64:79], a[208:211], a[136:139], v[64:79]
    v_mfma_f32_32x32x16_bf16 v[64:79], a[212:215], a[140:143], v[64:79]
    s_nop 15
    s_cmp_eq_u32 s55, 156672
    s_cbranch_scc1 L_redo2e_ob
    v_exp_f32 v64, v64
    v_exp_f32 v65, v65
    v_exp_f32 v66, v66
    v_exp_f32 v67, v67
    v_exp_f32 v68, v68
    v_exp_f32 v69, v69
    v_exp_f32 v70, v70
    v_exp_f32 v71, v71
    v_exp_f32 v72, v72
    v_exp_f32 v73, v73
    v_exp_f32 v74, v74
    v_exp_f32 v75, v75
    v_exp_f32 v76, v76
    v_exp_f32 v77, v77
    v_exp_f32 v78, v78
    v_exp_f32 v79, v79
    s_nop 0
    v_add_f32 v18, v18, v64
    v_add_f32 v18, v18, v65
    v_add_f32 v18, v18, v66
    v_add_f32 v18, v18, v67
    v_add_f32 v18, v18, v68
    v_add_f32 v18, v18, v69
    v_add_f32 v18, v18, v70
    v_add_f32 v18, v18, v71
    v_add_f32 v18, v18, v72
    v_add_f32 v18, v18, v73
    v_add_f32 v18, v18, v74
    v_add_f32 v18, v18, v75
    v_add_f32 v18, v18, v76
    v_add_f32 v18, v18, v77
    v_add_f32 v18, v18, v78
    v_add_f32 v18, v18, v79
    v_cvt_pk_bf16_f32 v64, v64, v65
    v_cvt_pk_bf16_f32 v65, v66, v67
    v_cvt_pk_bf16_f32 v66, v68, v69
    v_cvt_pk_bf16_f32 v67, v70, v71
    v_cvt_pk_bf16_f32 v72, v72, v73
    v_cvt_pk_bf16_f32 v73, v74, v75
    v_cvt_pk_bf16_f32 v74, v76, v77
    v_cvt_pk_bf16_f32 v75, v78, v79
    s_nop 1
    v_mfma_f32_32x32x16_bf16 v[208:223], a[216:219], v[64:67], v[208:223]
    v_mfma_f32_32x32x16_bf16 v[224:239], a[220:223], v[64:67], v[224:239]
    v_mfma_f32_32x32x16_bf16 v[240:255], a[224:227], v[64:67], v[240:255]
    v_mfma_f32_32x32x16_bf16 v[208:223], a[228:231], v[72:75], v[208:223]
    v_mfma_f32_32x32x16_bf16 v[224:239], a[232:235], v[72:75], v[224:239]
    v_mfma_f32_32x32x16_bf16 v[240:255], a[236:239], v[72:75], v[240:255]
    s_add_u32 s55, s55, 6528
    s_branch L_redo2_ob
L_redo2e_ob:
    v_exp_f32 v64, v64
    v_exp_f32 v65, v65
    v_exp_f32 v66, v66
    v_exp_f32 v67, v67
    v_exp_f32 v68, v68
    v_exp_f32 v69, v69
    v_exp_f32 v70, v70
    v_exp_f32 v71, v71
    s_nop 0
    v_add_f32 v18, v18, v64
    v_add_f32 v18, v18, v65
    v_add_f32 v18, v18, v66
    v_add_f32 v18, v18, v67
    v_add_f32 v18, v18, v68
    v_add_f32 v18, v18, v69
    v_add_f32 v18, v18, v70
    v_add_f32 v18, v18, v71
    v_cvt_pk_bf16_f32 v64, v64, v65
    v_cvt_pk_bf16_f32 v65, v66, v67
    v_cvt_pk_bf16_f32 v66, v68, v69
    v_cvt_pk_bf16_f32 v67, v70, v71
    s_nop 1
    v_mfma_f32_32x32x16_bf16 v[208:223], a[216:219], v[64:67], v[208:223]
    v_mfma_f32_32x32x16_bf16 v[224:239], a[220:223], v[64:67], v[224:239]
    v_mfma_f32_32x32x16_bf16 v[240:255], a[224:227], v[64:67], v[240:255]
    v_mov_b32 v2, v18
    s_nop 1
    v_permlane32_swap_b32 v18, v2
    s_nop 0
    v_add_f32 v2, v18, v2
    s_nop 15
    s_branch L_redone_ob
L_end:
    s_endpgm
.section .rodata,"a"
.p2align 6
.amdhsa_kernel standalone__window_attn_twins__vision_kernel
  .amdhsa_next_free_vgpr 512
  .amdhsa_next_free_sgpr 102
  .amdhsa_accum_offset 256
  .amdhsa_group_segment_fixed_size 0
  .amdhsa_kernarg_size 56
  .amdhsa_user_sgpr_count 2
  .amdhsa_user_sgpr_kernarg_segment_ptr 1
  .amdhsa_system_sgpr_workgroup_id_x 1
.end_amdhsa_kernel
```
